```python
import torch

def _softmax(x, axis=-1):
    return torch.softmax(x, dim=axis)
def _gelu(x):
    return torch.nn.functional.gelu(x, approximate="tanh")
def _silu(x):
    return torch.nn.functional.silu(x)
def _sigmoid(x):
    return torch.sigmoid(x)
def _layernorm(x, axis=-1, eps=1e-5):
    m = x.mean(dim=axis, keepdim=True)
    v = x.var(dim=axis, keepdim=True, unbiased=False)
    return (x - m) / torch.sqrt(v + eps)
def _scatter_add(tgt, idx, src, axis=0):
    return tgt.clone().index_add_(axis, idx, src)
def _segment_sum(src, seg, n):
    out = torch.zeros((n,) + src.shape[1:], dtype=src.dtype)
    return out.index_add_(0, seg, src)
def _pad(x, pw):
    flat = tuple(v for pair in reversed(pw) for v in pair)
    return torch.nn.functional.pad(x, flat)

kernel_name = 'sequential_preLN__ssm_conv_s4__mixer_token_mlp__prompt'

def setup_inputs():

    _w = (lambda a: (lambda t: t.to(torch.bfloat16) if t.is_floating_point() else t)(torch.as_tensor(a)))
    def _A_setup():
        B, L, D, N = 1, 2048, 512, 128
        A_re = -(lambda _x: torch.exp(torch.as_tensor(_x)))((lambda *s: torch.randn(*s, dtype=torch.bfloat16) * 6.4)(D, N))
        A_im = torch.pi * (lambda *s: torch.randn(*s, dtype=torch.bfloat16) * 0.05)(D, N)
        B_re = (lambda *s: torch.randn(*s, dtype=torch.bfloat16) * 0.1)(D, N)
        B_im = (lambda *s: torch.randn(*s, dtype=torch.bfloat16) * 0.1)(D, N)
        C_re = (lambda *s: torch.randn(*s, dtype=torch.bfloat16) * 0.1)(D, N)
        C_im = (lambda *s: torch.randn(*s, dtype=torch.bfloat16) * 0.1)(D, N)
        log_dt = (lambda *s: torch.randn(*s, dtype=torch.bfloat16) * 0.05)(D) * 0.5 - 4.0
        Dskip = (lambda *s: torch.randn(*s, dtype=torch.bfloat16) * 0.05)(D)
        return {
            "u": _w((lambda *s: torch.randn(*s, dtype=torch.bfloat16) * 0.05)(B, L, D)),
            "A_re": _w(A_re),
            "A_im": _w(A_im),
            "B_re": _w(B_re),
            "B_im": _w(B_im),
            "C_re": _w(C_re),
            "C_im": _w(C_im),
            "log_dt": _w(log_dt),
            "Dskip": _w(Dskip),
        }
    _A_in = _A_setup()

    def _B_setup():
        B, S, D, F = 1, 2048, 512, 1792
        return {
            "x": _w((lambda *s: torch.randn(*s, dtype=torch.bfloat16) * 0.05)(B, S, D)),
            "w1": _w((lambda *s: torch.randn(*s, dtype=torch.bfloat16) * 0.4)(S, F) * (S ** -0.5)),
            "b1": _w((lambda *s: torch.randn(*s, dtype=torch.bfloat16) * 0.1)(F) * 0.02),
            "w2": _w((lambda *s: torch.randn(*s, dtype=torch.bfloat16) * 0.1)(F, S) * (F ** -0.5)),
            "b2": _w((lambda *s: torch.randn(*s, dtype=torch.bfloat16) * 0.1)(S) * 0.02),
        }
    _B_in = _B_setup()

    return {
        "A_u": _A_in["u"],
        "A_A_re": _A_in["A_re"],
        "A_A_im": _A_in["A_im"],
        "A_B_re": _A_in["B_re"],
        "A_B_im": _A_in["B_im"],
        "A_C_re": _A_in["C_re"],
        "A_C_im": _A_in["C_im"],
        "A_log_dt": _A_in["log_dt"],
        "A_Dskip": _A_in["Dskip"],
        "B_x": _B_in["x"],
        "B_w1": _B_in["w1"],
        "B_b1": _B_in["b1"],
        "B_w2": _B_in["w2"],
        "B_b2": _B_in["b2"],
    }

def reference(A_u, A_A_re, A_A_im, A_B_re, A_B_im, A_C_re, A_C_im, A_log_dt, A_Dskip, B_x, B_w1, B_b1, B_w2, B_b2):
    def _A_ref(u, A_re, A_im, B_re, B_im, C_re, C_im, log_dt, Dskip):
        Bsz, L, D = u.shape
        dt = torch.exp(log_dt)[:, None]
        A = A_re + 1j * A_im
        Bc = B_re + 1j * B_im
        Cc = C_re + 1j * C_im
        logdA = dt * A
        dB = dt * Bc
        l = (lambda x, dt: x.to(dt))(torch.arange(L), A_re.dtype)
        P = torch.exp(logdA[:, :, None] * l[None, None, :])
        K = torch.einsum("dn,dnl,dn->dl", Cc, P, dB).real
        L2 = 2 * L
        Kp = _pad(K, ((0, 0), (0, L)))
        up = (lambda x, *d: x.permute(*d))(u, 0, 2, 1)
        up = _pad(up, ((0, 0), (0, 0), (0, L)))
        Kf = (lambda x, axes=(-2,-1): torch.fft.rfft2(x.float(), dim=axes))(Kp[:, None, :], axes=(-2, -1))
        Uf = (lambda x, axes=(-2,-1): torch.fft.rfft2(x.float(), dim=axes))(up[:, :, None, :], axes=(-2, -1))
        Yf = Uf * Kf[None, :, :, :]
        y = (lambda x, s, axes=(-2,-1): torch.fft.irfft2(x, s=s, dim=axes).to(torch.bfloat16))(Yf, (1, L2), axes=(-2, -1))[:, :, 0, :L]
        y = (lambda x, *d: x.permute(*d))(y, 0, 2, 1) + u * Dskip[None, None, :]
        return y

    def _B_ref(x, w1, b1, w2, b2):
        B, S, D = x.shape
        h = _layernorm(x, axis=-1)
        u = torch.einsum("bsd,sf->bdf", h, w1) + b1
        u = _gelu(u)
        y = torch.einsum("bdf,fs->bds", u, w2) + b2
        return (lambda x, *d: x.permute(*d))(y, 0, 2, 1)

    x = A_u
    h = x + _A_ref(_layernorm(x, axis=-1), A_A_re, A_A_im, A_B_re, A_B_im, A_C_re, A_C_im, A_log_dt, A_Dskip)
    h2 = h + _B_ref(_layernorm(h, axis=-1), B_w1, B_b1, B_w2, B_b2)
    return h2
```

```asm
; @launch grid=(256,1,1) block=(256,1,1) lds=163840
.amdgcn_target "amdgcn-amd-amdhsa--gfx950"
.text
.globl sequential_preLN__ssm_conv_s4__mixer_token_mlp__prompt_kernel
.p2align 8
.type sequential_preLN__ssm_conv_s4__mixer_token_mlp__prompt_kernel,@function
sequential_preLN__ssm_conv_s4__mixer_token_mlp__prompt_kernel:
    s_cmp_ge_u32 s2, 256
    s_cbranch_scc1 L_exit
    s_nop 0
    s_load_dwordx16 s[64:79], s[0:1], 0
    s_load_dwordx2 s[88:89], s[0:1], 64
    s_load_dwordx4 s[80:83], s[0:1], 80
    s_load_dwordx4 s[84:87], s[0:1], 96
    s_load_dwordx4 s[60:63], s[0:1], 112
    s_load_dwordx2 s[6:7], s[0:1], 128
    v_lshrrev_b32 v1, 6, v0
    v_and_b32 v2, 63, v0
    v_readfirstlane_b32 s10, v1
    s_and_b32 s54, s2, 7
    s_lshl_b32 s54, s54, 5
    s_lshr_b32 s55, s2, 3
    s_add_u32 s5, s54, s55
    s_lshl_b32 s11, s5, 1
    s_lshr_b32 s55, s10, 1
    s_add_u32 s56, s11, s55
    s_and_b32 s57, s56, 0x1c0
    s_and_b32 s58, s56, 7
    s_lshl_b32 s58, s58, 3
    s_or_b32 s57, s57, s58
    s_lshr_b32 s58, s56, 3
    s_and_b32 s58, s58, 7
    s_or_b32 s57, s57, s58
    v_lshlrev_b32 v3, 4, v2
    s_lshl_b32 s58, s5, 13
    s_lshl_b32 s59, s10, 11
    s_add_u32 s59, s59, s58
    s_and_b32 s54, s10, 1
    s_lshl_b32 s54, s54, 7
    s_lshl_b32 s55, s57, 8
    s_add_u32 s54, s54, s55
    v_lshl_add_u32 v12, v2, 1, s54
    v_xor_b32 v13, 128, v12
    s_waitcnt lgkmcnt(0)
    s_mov_b32 s12, s64
    s_mov_b32 s13, s65
    s_nop 0
    s_mov_b32 s14, 2097152
    s_mov_b32 s15, 0x20000
    buffer_load_dwordx4 v[224:227], v3, s[12:15], s59 offen
    buffer_load_dwordx4 v[228:231], v3, s[12:15], s59 offen offset:1024
    global_load_ushort v200, v12, s[66:67]
    global_load_ushort v201, v12, s[68:69]
    global_load_ushort v202, v12, s[70:71]
    global_load_ushort v203, v12, s[72:73]
    global_load_ushort v204, v12, s[74:75]
    global_load_ushort v205, v12, s[76:77]
    global_load_ushort v206, v13, s[70:71]
    global_load_ushort v207, v13, s[72:73]
    global_load_ushort v208, v13, s[74:75]
    global_load_ushort v209, v13, s[76:77]
    s_lshl_b32 s54, s57, 1
    s_and_b32 s54, s54, 0xfffffffc
    s_load_dword s52, s[78:79], s54
    s_load_dword s53, s[88:89], s54
    s_and_b32 s91, s57, 1
    s_mov_b32 s8, s62
    s_mov_b32 s9, s63
    s_mov_b32 s44, s60
    s_mov_b32 s45, s61
    s_mov_b32 s46, 2097152
    s_mov_b32 s47, 0x20000
    s_mov_b32 s16, s6
    s_mov_b32 s17, s7
    s_mov_b32 s18, 2097152
    s_mov_b32 s19, 0x20000
    s_add_u32 s20, s6, 4325376
    s_addc_u32 s21, s7, 0
    s_mov_b32 s22, 2097152
    s_mov_b32 s23, 0x20000
    s_add_u32 s24, s6, 6422528
    s_addc_u32 s25, s7, 0
    s_mov_b32 s26, 2097152
    s_mov_b32 s27, 0x20000
    s_add_u32 s28, s6, 8519680
    s_addc_u32 s29, s7, 0
    s_mov_b32 s30, 2097152
    s_mov_b32 s31, 0x20000
    s_add_u32 s32, s6, 10616832
    s_addc_u32 s33, s7, 0
    s_mov_b32 s34, 1835008
    s_mov_b32 s35, 0x20000
    s_mov_b32 s36, s80
    s_mov_b32 s37, s81
    s_mov_b32 s38, 7340032
    s_mov_b32 s39, 0x20000
    s_mov_b32 s40, s84
    s_mov_b32 s41, s85
    s_mov_b32 s42, 7340032
    s_mov_b32 s43, 0x20000
    s_mov_b32 s48, s82
    s_mov_b32 s49, s83
    s_mov_b32 s50, s86
    s_mov_b32 s51, s87
    s_add_u32 s80, s6, 16777216
    s_addc_u32 s81, s7, 0
    s_mov_b32 s82, 7340032
    s_mov_b32 s83, 0x20000
    s_or_b32 s54, s2, s10
    s_cmp_lg_u32 s54, 0
    s_cbranch_scc1 L_z1
    v_lshlrev_b32 v14, 7, v2
    v_add_u32 v14, 12582912, v14
    v_mov_b32_e64 v15, 0
    global_store_dword v14, v15, s[6:7] sc1
L_z1:
    s_cmp_lg_u32 s10, 3
    s_cbranch_scc1 L_cpf2
    s_getpc_b64 s[54:55]
L_pcbase:
    v_lshlrev_b32 v14, 7, v2
    s_mov_b32 s56, L_code_end-L_pcbase
    v_min_u32_e64 v15, s56, v14
    global_load_dword a198, v15, s[54:55]
    v_add_u32 v14, 8192, v14
    v_min_u32_e64 v15, s56, v14
    global_load_dword a198, v15, s[54:55]
    v_add_u32 v14, 8192, v14
    v_min_u32_e64 v15, s56, v14
    global_load_dword a198, v15, s[54:55]
    v_add_u32 v14, 8192, v14
    v_min_u32_e64 v15, s56, v14
    global_load_dword a198, v15, s[54:55]
    v_add_u32 v14, 8192, v14
    v_min_u32_e64 v15, s56, v14
    global_load_dword a198, v15, s[54:55]
L_cpf2:
    s_and_b32 s60, s2, 7
    s_lshr_b32 s60, s60, 1
    s_lshr_b32 s61, s2, 3
    s_and_b32 s62, s10, 1
    s_lshl_b32 s62, s62, 9
    s_lshl_b32 s63, s61, 6
    v_add_u32_e64 v1, s63, v2
    v_mul_u32_u24 v1, 3584, v1
    s_mul_i32 s63, s60, 896
    s_add_u32 s63, s63, s62
    v_add_u32 v1, s63, v1
    s_mul_i32 s79, s2, 28672
    s_and_b32 s61, s10, 1
    s_mul_i32 s61, s61, 14336
    s_add_u32 s79, s79, s61
    s_cmp_lt_u32 s10, 2
    s_cbranch_scc1 L_bk3
    buffer_load_dword a199, v1, s[36:39], 0 offen offset:0
L_bk3:
    v_lshrrev_b32_e64 v4, 3, v2
    v_mul_u32_u24 v4, 72, v4
    v_and_b32 v5, 7, v2
    v_add_u32 v4, v4, v5
    s_mul_i32 s54, s10, 576
    v_add_u32 v4, s54, v4
    v_lshlrev_b32 v252, 2, v4
    v_add_u32 v252, 67744, v252
    s_mul_i32 s54, s10, 72
    v_add_u32 v4, s54, v2
    v_lshlrev_b32 v253, 2, v4
    v_add_u32 v253, 67744, v253
    v_lshlrev_b32 v254, 4, v0
    s_lshr_b32 s60, s10, 1
    s_mul_i32 s60, s60, 27984
    s_and_b32 s62, s10, 1
    s_lshl_b32 s61, s62, 8
    s_add_u32 s61, s61, s60
    v_lshl_add_u32 v232, v2, 2, s61
    v_and_b32 v7, 15, v2
    v_lshrrev_b32_e64 v8, 4, v2
    v_mul_u32_u24 v9, 528, v7
    v_lshl_add_u32 v9, v8, 4, v9
    s_mul_i32 s63, s62, 8448
    s_add_u32 s63, s63, s60
    v_add_u32 v233, s63, v9
    s_add_u32 s63, s60, 11088
    v_add_u32 v234, s63, v9
    v_lshlrev_b32 v16, 3, v7
    s_lshr_b32 s63, s10, 1
    s_mul_i32 s63, s63, 5888
    s_add_u32 s63, s63, 55968
    s_movk_i32 s54, 2304
    v_cmp_eq_u32 s[56:57], 1, v8
    v_cmp_eq_u32 s[58:59], 2, v8
    v_cmp_eq_u32 vcc, 3, v8
    s_cmp_eq_u32 s62, 0
    s_cselect_b32 s55, 0, 1024
    v_mov_b32_e64 v235, s55
    s_cselect_b32 s55, 4, 2048
    v_mov_b32_e64 v18, s55
    v_cndmask_b32 v235, v235, v18, s[56:57]
    s_cselect_b32 s55, 256, s54
    v_mov_b32_e64 v18, s55
    v_cndmask_b32 v235, v235, v18, s[58:59]
    s_cselect_b32 s55, 512, s54
    v_mov_b32 v18, s55
    v_cndmask_b32 v235, v235, v18, vcc
    v_add_u32 v235, v235, v16
    v_lshrrev_b32 v18, 4, v235
    v_lshlrev_b32_e64 v18, 2, v18
    v_lshl_add_u32 v235, v235, 1, v18
    v_add_u32 v235, s63, v235
    s_cmp_eq_u32 s62, 0
    s_cselect_b32 s55, 1, 1280
    v_mov_b32_e64 v236, s55
    s_cselect_b32 s55, 5, 2304
    v_mov_b32_e64 v18, s55
    v_cndmask_b32 v236, v236, v18, s[56:57]
    s_cselect_b32 s55, 258, s54
    v_mov_b32_e64 v18, s55
    v_cndmask_b32 v236, v236, v18, s[58:59]
    s_cselect_b32 s55, 516, s54
    v_mov_b32 v18, s55
    v_cndmask_b32 v236, v236, v18, vcc
    v_add_u32 v236, v236, v16
    v_lshrrev_b32 v18, 4, v236
    v_lshlrev_b32_e64 v18, 2, v18
    v_lshl_add_u32 v236, v236, 1, v18
    v_add_u32 v236, s63, v236
    s_cmp_eq_u32 s62, 0
    s_cselect_b32 s55, 2, 1536
    v_mov_b32_e64 v237, s55
    s_cselect_b32 s55, 6, 2304
    v_mov_b32_e64 v18, s55
    v_cndmask_b32 v237, v237, v18, s[56:57]
    s_cselect_b32 s55, 260, s54
    v_mov_b32_e64 v18, s55
    v_cndmask_b32 v237, v237, v18, s[58:59]
    s_cselect_b32 s55, 768, s54
    v_mov_b32 v18, s55
    v_cndmask_b32 v237, v237, v18, vcc
    v_add_u32 v237, v237, v16
    v_lshrrev_b32 v18, 4, v237
    v_lshlrev_b32_e64 v18, 2, v18
    v_lshl_add_u32 v237, v237, 1, v18
    v_add_u32 v237, s63, v237
    s_cmp_eq_u32 s62, 0
    s_cselect_b32 s55, 3, 1792
    v_mov_b32_e64 v238, s55
    s_cselect_b32 s55, 7, 2304
    v_mov_b32_e64 v18, s55
    v_cndmask_b32 v238, v238, v18, s[56:57]
    s_cselect_b32 s55, 262, s54
    v_mov_b32_e64 v18, s55
    v_cndmask_b32 v238, v238, v18, s[58:59]
    s_cselect_b32 s55, 772, s54
    v_mov_b32 v18, s55
    v_cndmask_b32 v238, v238, v18, vcc
    v_add_u32 v238, v238, v16
    v_lshrrev_b32 v18, 4, v238
    v_lshlrev_b32_e64 v18, 2, v18
    v_lshl_add_u32 v238, v238, 1, v18
    v_add_u32 v238, s63, v238
    s_lshl_b32 s55, s62, 6
    v_add_u32 v19, s55, v2
    v_lshlrev_b32 v100, 5, v19
    v_sub_u32 v100, 4094, v100
    v_subrev_u32 v104, 0, v100
    v_cvt_f32_u32 v104, v104
    v_subrev_u32 v105, 2, v100
    v_cvt_f32_u32 v105, v105
    v_subrev_u32 v106, 4, v100
    v_cvt_f32_u32 v106, v106
    v_subrev_u32 v107, 6, v100
    v_cvt_f32_u32 v107, v107
    v_subrev_u32 v108, 8, v100
    v_cvt_f32_u32 v108, v108
    v_subrev_u32 v109, 10, v100
    v_cvt_f32_u32 v109, v109
    v_subrev_u32 v110, 12, v100
    v_cvt_f32_u32 v110, v110
    v_subrev_u32 v111, 14, v100
    v_cvt_f32_u32 v111, v111
    v_subrev_u32 v112, 16, v100
    v_cvt_f32_u32 v112, v112
    v_subrev_u32 v113, 18, v100
    v_cvt_f32_u32 v113, v113
    v_subrev_u32 v114, 20, v100
    v_cvt_f32_u32 v114, v114
    v_subrev_u32 v115, 22, v100
    v_cvt_f32_u32 v115, v115
    v_subrev_u32 v116, 24, v100
    v_cvt_f32_u32 v116, v116
    v_subrev_u32 v117, 26, v100
    v_cvt_f32_u32 v117, v117
    v_subrev_u32 v118, 28, v100
    v_cvt_f32_u32 v118, v118
    v_subrev_u32 v119, 30, v100
    v_cvt_f32_u32 v119, v119
    v_subrev_u32 v120, 32, v100
    v_cvt_f32_u32 v120, v120
    v_subrev_u32 v121, 34, v100
    v_cvt_f32_u32 v121, v121
    v_subrev_u32 v122, 36, v100
    v_cvt_f32_u32 v122, v122
    v_cvt_pk_bf16_f32 v124, v104, v105
    v_cvt_pk_bf16_f32 v125, v106, v107
    v_cvt_pk_bf16_f32 v126, v108, v109
    v_cvt_pk_bf16_f32 v127, v110, v111
    v_cvt_pk_bf16_f32 v128, v112, v113
    v_cvt_pk_bf16_f32 v129, v114, v115
    v_cvt_pk_bf16_f32 v130, v116, v117
    v_cvt_pk_bf16_f32 v131, v118, v119
    v_cvt_pk_bf16_f32 v132, v120, v121
    v_cvt_pk_bf16_f32 v133, v122, v122
    v_lshlrev_b32_e64 v104, 16, v124
    v_and_b32 v105, 0xffff0000, v124
    v_lshlrev_b32_e64 v106, 16, v125
    v_and_b32 v107, 0xffff0000, v125
    v_lshlrev_b32_e64 v108, 16, v126
    v_and_b32 v109, 0xffff0000, v126
    v_lshlrev_b32_e64 v110, 16, v127
    v_and_b32 v111, 0xffff0000, v127
    v_lshlrev_b32_e64 v112, 16, v128
    v_and_b32 v113, 0xffff0000, v128
    v_lshlrev_b32_e64 v114, 16, v129
    v_and_b32 v115, 0xffff0000, v129
    v_lshlrev_b32_e64 v116, 16, v130
    v_and_b32 v117, 0xffff0000, v130
    v_lshlrev_b32_e64 v118, 16, v131
    v_and_b32 v119, 0xffff0000, v131
    v_lshlrev_b32_e64 v120, 16, v132
    v_and_b32 v121, 0xffff0000, v132
    v_lshlrev_b32 v122, 16, v133
    v_cvt_u32_f32 v104, v104
    v_cvt_u32_f32 v105, v105
    v_cvt_u32_f32 v106, v106
    v_cvt_u32_f32 v107, v107
    v_cvt_u32_f32 v108, v108
    v_cvt_u32_f32 v109, v109
    v_cvt_u32_f32 v110, v110
    v_cvt_u32_f32 v111, v111
    v_cvt_u32_f32 v112, v112
    v_cvt_u32_f32 v113, v113
    v_cvt_u32_f32 v114, v114
    v_cvt_u32_f32 v115, v115
    v_cvt_u32_f32 v116, v116
    v_cvt_u32_f32 v117, v117
    v_cvt_u32_f32 v118, v118
    v_cvt_u32_f32 v119, v119
    v_cvt_u32_f32 v120, v120
    v_cvt_u32_f32 v121, v121
    v_cvt_u32_f32 v122, v122
    v_min_u32 v120, 4120, v120
    v_min_u32 v121, 4120, v121
    v_min_u32 v122, 4120, v122
    v_lshrrev_b32_e64 v18, 5, v104
    v_lshl_add_u32 v104, v18, 2, v104
    v_add_u32 v104, s63, v104
    v_lshrrev_b32 v18, 5, v105
    v_lshl_add_u32 v105, v18, 2, v105
    v_add_u32 v105, s63, v105
    v_lshrrev_b32 v18, 5, v106
    v_lshl_add_u32 v106, v18, 2, v106
    v_add_u32 v106, s63, v106
    v_lshrrev_b32 v18, 5, v107
    v_lshl_add_u32 v107, v18, 2, v107
    v_add_u32 v107, s63, v107
    v_lshrrev_b32 v18, 5, v108
    v_lshl_add_u32 v108, v18, 2, v108
    v_add_u32 v108, s63, v108
    v_lshrrev_b32 v18, 5, v109
    v_lshl_add_u32 v109, v18, 2, v109
    v_add_u32 v109, s63, v109
    v_lshrrev_b32 v18, 5, v110
    v_lshl_add_u32 v110, v18, 2, v110
    v_add_u32 v110, s63, v110
    v_lshrrev_b32 v18, 5, v111
    v_lshl_add_u32 v111, v18, 2, v111
    v_add_u32 v111, s63, v111
    v_lshrrev_b32 v18, 5, v112
    v_lshl_add_u32 v112, v18, 2, v112
    v_add_u32 v112, s63, v112
    v_lshrrev_b32 v18, 5, v113
    v_lshl_add_u32 v113, v18, 2, v113
    v_add_u32 v113, s63, v113
    v_lshrrev_b32 v18, 5, v114
    v_lshl_add_u32 v114, v18, 2, v114
    v_add_u32 v114, s63, v114
    v_lshrrev_b32 v18, 5, v115
    v_lshl_add_u32 v115, v18, 2, v115
    v_add_u32 v115, s63, v115
    v_lshrrev_b32 v18, 5, v116
    v_lshl_add_u32 v116, v18, 2, v116
    v_add_u32 v116, s63, v116
    v_lshrrev_b32 v18, 5, v117
    v_lshl_add_u32 v117, v18, 2, v117
    v_add_u32 v117, s63, v117
    v_lshrrev_b32 v18, 5, v118
    v_lshl_add_u32 v118, v18, 2, v118
    v_add_u32 v118, s63, v118
    v_lshrrev_b32 v18, 5, v119
    v_lshl_add_u32 v119, v18, 2, v119
    v_add_u32 v119, s63, v119
    v_lshrrev_b32 v18, 5, v120
    v_lshl_add_u32 v120, v18, 2, v120
    v_add_u32 v120, s63, v120
    v_lshrrev_b32 v18, 5, v121
    v_lshl_add_u32 v121, v18, 2, v121
    v_add_u32 v121, s63, v121
    v_lshrrev_b32 v18, 5, v122
    v_lshl_add_u32 v122, v18, 2, v122
    v_add_u32 v122, s63, v122
    s_lshr_b32 s55, s10, 1
    s_mul_i32 s55, s55, 16640
    s_add_u32 s55, s55, 0
    v_lshlrev_b32 v19, 5, v19
    v_add_u32 v239, s55, v19
    s_cmp_lt_u32 s10, 2
    s_cbranch_scc1 L_bk4
    buffer_load_dword a199, v1, s[36:39], 0 offen offset:128
L_bk4:
    s_lshr_b32 s60, s10, 1
    s_and_b32 s61, s10, 1
    v_and_b32 v52, 31, v2
    v_lshrrev_b32 v53, 5, v2
    v_and_b32 v54, 3, v52
    v_sub_u32_e64 v54, 3, v54
    v_mul_u32_u24 v54, 4160, v54
    v_lshrrev_b32 v55, 2, v52
    v_lshlrev_b32 v55, 3, v55
    v_sub_u32_e64 v54, v54, v55
    v_lshl_add_u32 v54, v53, 4, v54
    s_mul_i32 s62, s60, 16640
    s_lshl_b32 s63, s61, 6
    s_sub_u32 s62, s62, s63
    s_add_u32 s62, s62, 120
    v_add_u32_e64 v248, s62, v54
    v_mul_u32_u24 v55, 80, v52
    v_lshl_add_u32 v55, v53, 4, v55
    s_mul_i32 s62, s60, 7600
    s_mul_i32 s63, s61, 80
    s_sub_u32 s62, s62, s63
    s_add_u32 s62, s62, 33360
    v_add_u32 v249, s62, v55
    s_and_b32 s60, s2, 7
    s_lshr_b32 s61, s2, 3
    s_and_b32 s54, s60, 1
    s_lshl_b32 s54, s54, 2
    s_and_b32 s62, s61, 3
    s_add_u32 s54, s54, s62
    s_lshr_b32 s55, s60, 1
    s_mul_i32 s55, s55, 7
    s_lshr_b32 s62, s61, 2
    s_add_u32 s55, s55, s62
    s_and_b32 s60, s2, 7
    s_lshr_b32 s61, s2, 3
    s_and_b32 s56, s60, 1
    s_lshl_b32 s56, s56, 2
    s_and_b32 s62, s61, 3
    s_add_u32 s56, s56, s62
    s_lshr_b32 s57, s60, 1
    s_mul_i32 s57, s57, 8
    s_lshr_b32 s62, s61, 2
    s_add_u32 s57, s57, s62
    v_lshrrev_b32_e64 v240, 3, v2
    v_mul_u32_u24 v240, 3584, v240
    v_and_b32 v243, 7, v2
    v_lshrrev_b32 v244, 2, v2
    v_and_b32 v244, 4, v244
    v_xor_b32 v243, v243, v244
    v_lshl_add_u32 v240, v243, 4, v240
    v_bfe_u32 v243, v2, 2, 2
    v_and_b32_e64 v244, 3, v2
    v_bfe_u32 v241, v2, 4, 1
    v_lshlrev_b32 v241, 1, v241
    v_lshrrev_b32 v245, 1, v244
    v_add_u32 v241, v241, v245
    v_lshrrev_b32 v245, 1, v243
    v_lshlrev_b32 v245, 2, v245
    v_xor_b32 v241, v241, v245
    v_lshlrev_b32 v241, 4, v241
    v_and_b32 v245, 1, v244
    v_lshl_add_u32 v241, v245, 3, v241
    v_lshrrev_b32 v245, 5, v2
    v_lshlrev_b32 v245, 3, v245
    v_add_u32_e64 v245, v245, v243
    v_lshl_add_u32 v241, v245, 7, v241
    v_xor_b32 v242, 64, v241
    s_cmp_eq_u32 s91, 1
    s_cselect_b32 s60, 0, 16
    s_waitcnt lgkmcnt(0)
    s_lshl_b32 s52, s52, s60
    s_and_b32 s52, s52, 0xffff0000
    s_lshl_b32 s53, s53, s60
    s_and_b32 s53, s53, 0xffff0000
    s_mov_b32 s90, 989855744
    s_mov_b32 s91, 925353388
    s_waitcnt vmcnt(10)
    v_lshlrev_b32 v16, 16, v224
    v_lshlrev_b32_e64 v17, 16, v228
    v_and_b32 v18, 0xffff0000, v224
    v_and_b32 v19, 0xffff0000, v228
    v_lshlrev_b32 v20, 16, v225
    v_lshlrev_b32 v21, 16, v229
    v_and_b32 v22, 0xffff0000, v225
    v_and_b32 v23, 0xffff0000, v229
    v_lshlrev_b32 v24, 16, v226
    v_lshlrev_b32 v25, 16, v230
    v_and_b32 v26, 0xffff0000, v226
    v_and_b32 v27, 0xffff0000, v230
    v_lshlrev_b32 v28, 16, v227
    v_lshlrev_b32 v29, 16, v231
    v_and_b32 v30, 0xffff0000, v227
    v_and_b32 v31, 0xffff0000, v231
    v_pk_add_f32 v[32:33], v[16:17], v[18:19]
    v_pk_mul_f32 v[34:35], v[16:17], v[16:17]
    v_pk_add_f32 v[36:37], v[20:21], v[22:23]
    v_pk_mul_f32 v[38:39], v[18:19], v[18:19]
    v_pk_fma_f32 v[34:35], v[20:21], v[20:21], v[34:35]
    v_pk_fma_f32 v[38:39], v[22:23], v[22:23], v[38:39]
    v_pk_fma_f32 v[34:35], v[24:25], v[24:25], v[34:35]
    v_pk_add_f32 v[32:33], v[32:33], v[24:25]
    v_pk_fma_f32 v[38:39], v[26:27], v[26:27], v[38:39]
    v_pk_add_f32 v[36:37], v[36:37], v[26:27]
    v_pk_fma_f32 v[34:35], v[28:29], v[28:29], v[34:35]
    v_pk_add_f32 v[32:33], v[32:33], v[28:29]
    v_pk_fma_f32 v[38:39], v[30:31], v[30:31], v[38:39]
    v_pk_add_f32 v[36:37], v[36:37], v[30:31]
    v_pk_add_f32 v[32:33], v[32:33], v[36:37]
    v_pk_add_f32 v[34:35], v[34:35], v[38:39]
    s_nop 0
    v_permlane32_swap_b32 v32, v33
    v_permlane32_swap_b32 v34, v35
    v_add_f32 v32, v32, v33
    v_add_f32 v34, v34, v35
    s_nop 1
    v_permlane16_swap_b32 v32, v34
    v_add_f32 v32, v32, v34
    s_nop 1
    v_add_f32_dpp v32, v32, v32 row_ror:8 row_mask:0xf bank_mask:0xf
    s_nop 1
    v_add_f32_dpp v32, v32, v32 row_ror:4 row_mask:0xf bank_mask:0xf
    s_nop 1
    v_add_f32_dpp v32, v32, v32 row_ror:2 row_mask:0xf bank_mask:0xf
    s_nop 1
    v_add_f32_dpp v32, v32, v32 row_ror:1 row_mask:0xf bank_mask:0xf
    v_mov_b32 v33, v32
    s_nop 1
    v_permlane16_swap_b32 v32, v33
    v_mul_f32 v32, s90, v32
    v_mul_f32_e64 v33, s90, v33
    v_fma_f32 v33, -v32, v32, v33
    v_max_f32_e64 v33, 0, v33
    v_cvt_pk_bf16_f32 v36, v32, v33
    v_lshlrev_b32_e64 v32, 16, v36
    v_and_b32 v33, 0xffff0000, v36
    v_add_f32_e64 v33, s91, v33
    v_cvt_pk_bf16_f32 v33, v33, v33
    v_lshlrev_b32 v33, 16, v33
    v_sqrt_f32 v33, v33
    s_nop 0
    v_cvt_pk_bf16_f32 v33, v33, v33
    v_lshlrev_b32 v33, 16, v33
    v_rcp_f32_e64 v33, v33
    v_readlane_b32 s84, v32, 0
    v_readlane_b32 s85, v32, 32
    v_readlane_b32 s86, v33, 0
    v_readlane_b32 s87, v33, 32
    v_pk_add_f32 v[16:17], v[16:17], s[84:85] neg_lo:[0,1] neg_hi:[0,1]
    v_pk_add_f32 v[18:19], v[18:19], s[84:85] neg_lo:[0,1] neg_hi:[0,1]
    v_pk_add_f32 v[20:21], v[20:21], s[84:85] neg_lo:[0,1] neg_hi:[0,1]
    v_pk_add_f32 v[22:23], v[22:23], s[84:85] neg_lo:[0,1] neg_hi:[0,1]
    v_pk_add_f32 v[24:25], v[24:25], s[84:85] neg_lo:[0,1] neg_hi:[0,1]
    v_pk_add_f32 v[26:27], v[26:27], s[84:85] neg_lo:[0,1] neg_hi:[0,1]
    v_pk_add_f32 v[28:29], v[28:29], s[84:85] neg_lo:[0,1] neg_hi:[0,1]
    v_pk_add_f32 v[30:31], v[30:31], s[84:85] neg_lo:[0,1] neg_hi:[0,1]
    v_cvt_pk_bf16_f32 v40, v16, v17
    v_cvt_pk_bf16_f32 v41, v18, v19
    v_cvt_pk_bf16_f32 v42, v20, v21
    v_cvt_pk_bf16_f32 v43, v22, v23
    v_cvt_pk_bf16_f32 v44, v24, v25
    v_cvt_pk_bf16_f32 v45, v26, v27
    v_cvt_pk_bf16_f32 v46, v28, v29
    v_cvt_pk_bf16_f32 v47, v30, v31
    v_lshlrev_b32_e64 v16, 16, v40
    v_and_b32 v17, 0xffff0000, v40
    v_lshlrev_b32_e64 v18, 16, v41
    v_and_b32 v19, 0xffff0000, v41
    v_lshlrev_b32_e64 v20, 16, v42
    v_and_b32 v21, 0xffff0000, v42
    v_lshlrev_b32_e64 v22, 16, v43
    v_and_b32 v23, 0xffff0000, v43
    v_lshlrev_b32_e64 v24, 16, v44
    v_and_b32 v25, 0xffff0000, v44
    v_lshlrev_b32_e64 v26, 16, v45
    v_and_b32 v27, 0xffff0000, v45
    v_lshlrev_b32_e64 v28, 16, v46
    v_and_b32 v29, 0xffff0000, v46
    v_lshlrev_b32_e64 v30, 16, v47
    v_and_b32 v31, 0xffff0000, v47
    v_pk_mul_f32 v[16:17], v[16:17], s[86:87]
    v_pk_mul_f32 v[18:19], v[18:19], s[86:87]
    v_pk_mul_f32 v[20:21], v[20:21], s[86:87]
    v_pk_mul_f32 v[22:23], v[22:23], s[86:87]
    v_pk_mul_f32 v[24:25], v[24:25], s[86:87]
    v_pk_mul_f32 v[26:27], v[26:27], s[86:87]
    v_pk_mul_f32 v[28:29], v[28:29], s[86:87]
    v_pk_mul_f32 v[30:31], v[30:31], s[86:87]
    v_cvt_pk_bf16_f32 v40, v16, v17
    v_cvt_pk_bf16_f32 v41, v18, v19
    v_cvt_pk_bf16_f32 v42, v20, v21
    v_cvt_pk_bf16_f32 v43, v22, v23
    v_cvt_pk_bf16_f32 v44, v24, v25
    v_cvt_pk_bf16_f32 v45, v26, v27
    v_cvt_pk_bf16_f32 v46, v28, v29
    v_cvt_pk_bf16_f32 v47, v30, v31
    v_lshlrev_b32_e64 v16, 16, v40
    v_and_b32 v17, 0xffff0000, v40
    v_lshlrev_b32_e64 v18, 16, v41
    v_and_b32 v19, 0xffff0000, v41
    v_lshlrev_b32_e64 v20, 16, v42
    v_and_b32 v21, 0xffff0000, v42
    v_lshlrev_b32_e64 v22, 16, v43
    v_and_b32 v23, 0xffff0000, v43
    v_lshlrev_b32_e64 v24, 16, v44
    v_and_b32 v25, 0xffff0000, v44
    v_lshlrev_b32_e64 v26, 16, v45
    v_and_b32 v27, 0xffff0000, v45
    v_lshlrev_b32_e64 v28, 16, v46
    v_and_b32 v29, 0xffff0000, v46
    v_lshlrev_b32_e64 v30, 16, v47
    v_and_b32 v31, 0xffff0000, v47
    v_cvt_pk_f16_f32 v40, v16, v17
    v_cvt_pk_f16_f32 v41, v18, v19
    v_cvt_pk_f16_f32 v42, v20, v21
    v_cvt_pk_f16_f32 v43, v22, v23
    v_cvt_pk_f16_f32 v44, v24, v25
    v_cvt_pk_f16_f32 v45, v26, v27
    v_cvt_pk_f16_f32 v46, v28, v29
    v_cvt_pk_f16_f32 v47, v30, v31
    ds_write_b32 v252, v40 offset:0
    ds_write_b32 v252, v41 offset:32
    ds_write_b32 v252, v42 offset:64
    ds_write_b32 v252, v43 offset:96
    ds_write_b32 v252, v44 offset:128
    ds_write_b32 v252, v45 offset:160
    ds_write_b32 v252, v46 offset:192
    ds_write_b32 v252, v47 offset:224
    s_waitcnt lgkmcnt(0)
    s_barrier
    s_lshl_b32 s60, s5, 13
    s_cmp_ge_u32 s10, 2
    s_cbranch_scc1 L_po5
    v_add_u32 v64, 0, v253
    ds_read2st64_b32 v[48:49], v64 offset0:0 offset1:9
    ds_read2st64_b32 v[50:51], v64 offset0:18 offset1:27
    v_add_u32 v64, 576, v253
    ds_read2st64_b32 v[52:53], v64 offset0:0 offset1:9
    ds_read2st64_b32 v[54:55], v64 offset0:18 offset1:27
    v_add_u32 v64, 1152, v253
    ds_read2st64_b32 v[56:57], v64 offset0:0 offset1:9
    ds_read2st64_b32 v[58:59], v64 offset0:18 offset1:27
    v_add_u32 v64, 1728, v253
    ds_read2st64_b32 v[60:61], v64 offset0:0 offset1:9
    ds_read2st64_b32 v[62:63], v64 offset0:18 offset1:27
    s_waitcnt lgkmcnt(6)
    buffer_store_dwordx4 v[48:51], v254, s[16:19], s60 offen sc1
    s_add_u32 s60, s60, 2048
    s_waitcnt lgkmcnt(4)
    buffer_store_dwordx4 v[52:55], v254, s[16:19], s60 offen sc1
    s_add_u32 s60, s60, 2048
    s_waitcnt lgkmcnt(2)
    buffer_store_dwordx4 v[56:59], v254, s[16:19], s60 offen sc1
    s_add_u32 s60, s60, 2048
    s_waitcnt lgkmcnt(0)
    buffer_store_dwordx4 v[60:63], v254, s[16:19], s60 offen sc1
L_po5:
    s_and_b32 s60, s2, 3
    s_lshl_b32 s60, s60, 6
    s_cmp_ge_u32 s10, 2
    s_cbranch_scc1 L_ad6
    s_waitcnt vmcnt(0)
L_ad6:
    s_barrier
    s_cmp_lg_u32 s10, 0
    s_cbranch_scc1 L_arr7
    v_mov_b32 v13, s60
    v_mov_b32 v14, 1
    s_mov_b64 s[62:63], exec
    s_mov_b64 exec, 1
    global_atomic_add v13, v14, s[8:9] sc1
    s_mov_b64 exec, s[62:63]
L_arr7:
    s_waitcnt vmcnt(2)
    s_cmp_lt_u32 s10, 2
    s_cbranch_scc1 L_bk8
    buffer_load_dword a199, v1, s[36:39], 0 offen offset:256
L_bk8:
    s_lshr_b32 s60, s10, 1
    s_mul_i32 s60, s60, 27984
    s_mov_b32 s66, 1069066811
    s_mov_b32 s67, 849703008
    s_mov_b32 s68, 1060205080
    s_mov_b32 s69, 1042479491
    v_mov_b32 v20, s52
    v_mul_f32 v21, s66, v20
    v_fma_f32 v22, v20, s66, -v21
    v_fmac_f32 v22, s67, v20
    v_exp_f32 v21, v21
    v_mul_f32 v22, s68, v22
    v_fmac_f32 v21, v21, v22
    v_cvt_pk_bf16_f32 v21, v21, v21
    v_lshlrev_b32 v21, 16, v21
    v_lshlrev_b32 v10, 16, v200
    v_lshlrev_b32 v11, 16, v201
    v_lshlrev_b32 v12, 16, v202
    v_lshlrev_b32 v13, 16, v203
    v_lshlrev_b32 v14, 16, v204
    v_lshlrev_b32 v15, 16, v205
    v_lshlrev_b32 v16, 16, v206
    v_lshlrev_b32 v17, 16, v207
    v_lshlrev_b32 v18, 16, v208
    v_lshlrev_b32 v19, 16, v209
    v_mul_f32 v10, v21, v10
    v_mul_f32 v11, v21, v11
    v_mul_f32 v10, s66, v10
    v_mul_f32 v11, s69, v11
    v_mul_f32 v12, v21, v12
    v_mul_f32 v13, v21, v13
    v_mul_f32 v24, v14, v12
    v_mul_f32_e64 v25, v14, v13
    v_fma_f32 v24, -v15, v13, v24
    v_fmac_f32 v25, v15, v12
    v_mul_f32 v16, v21, v16
    v_mul_f32 v17, v21, v17
    v_mul_f32 v26, v18, v16
    v_mul_f32_e64 v27, v18, v17
    v_fma_f32 v26, -v19, v17, v26
    v_fmac_f32_e64 v27, v19, v16
    v_max3_f32 v28, abs(v24), abs(v25), abs(v26)
    v_max_f32 v28, v28, abs(v27)
    s_mov_b32 s78, 0x3f800000
    v_mul_f32 v40, s78, v10
    v_mul_f32 v41, s78, v11
    v_exp_f32 v40, v40
    v_rndne_f32 v42, v41
    v_sub_f32 v41, v41, v42
    v_cos_f32 v32, v41
    v_sin_f32 v33, v41
    v_mul_f32 v32, v32, v40
    v_mul_f32 v33, v33, v40
    v_max_f32_dpp v28, v28, v28 row_ror:8 row_mask:0xf bank_mask:0xf
    s_nop 1
    v_max_f32_dpp v28, v28, v28 row_ror:4 row_mask:0xf bank_mask:0xf
    s_nop 1
    v_max_f32_dpp v28, v28, v28 row_ror:2 row_mask:0xf bank_mask:0xf
    s_nop 1
    v_max_f32_dpp v28, v28, v28 row_ror:1 row_mask:0xf bank_mask:0xf
    v_mov_b32 v29, v28
    s_nop 1
    v_permlane16_swap_b32 v28, v29
    v_max_f32 v28, v28, v29
    v_mov_b32 v29, v28
    s_nop 1
    v_permlane32_swap_b32 v28, v29
    v_max_f32_e64 v28, v28, v29
    s_mov_b32 s78, 0x43800000
    v_mul_f32 v44, s78, v10
    v_mul_f32 v45, s78, v11
    v_exp_f32 v44, v44
    v_rndne_f32 v46, v45
    v_sub_f32 v45, v45, v46
    v_cos_f32 v34, v45
    v_sin_f32 v35, v45
    v_mul_f32 v34, v34, v44
    v_mul_f32 v35, v35, v44
    v_frexp_exp_i32_f32 v29, v28
    v_sub_u32_e64 v30, 0, v29
    v_ldexp_f32 v48, v24, v30
    v_ldexp_f32 v49, v25, v30
    v_mov_b32_e64 v31, 1.0
    v_ldexp_f32 v31, v31, v29
    s_mov_b32 s78, 0x41000000
    v_mul_f32 v40, s78, v10
    v_mul_f32 v41, s78, v11
    v_exp_f32 v40, v40
    v_rndne_f32 v42, v41
    v_sub_f32 v41, v41, v42
    v_cos_f32 v80, v41
    v_sin_f32 v81, v41
    v_mul_f32 v80, v80, v40
    v_mul_f32 v81, -v81, v40
    v_readfirstlane_b32 s52, v31
    s_mov_b32 s78, 0x43000000
    v_mul_f32 v44, s78, v10
    v_mul_f32 v45, s78, v11
    v_exp_f32 v44, v44
    v_rndne_f32 v46, v45
    v_sub_f32 v45, v45, v46
    v_cos_f32 v84, v45
    v_sin_f32 v85, v45
    v_mul_f32_e64 v84, v84, v44
    v_mul_f32 v85, -v85, v44
    v_pk_mul_f32 v[36:37], v[34:35], v[34:35] op_sel:[0,0] op_sel_hi:[0,1]
    v_pk_fma_f32 v[36:37], v[34:35], v[34:35], v[36:37] op_sel:[1,1,0] op_sel_hi:[1,0,1] neg_lo:[1,0,0]
    v_pk_mul_f32 v[38:39], v[36:37], v[36:37] op_sel:[0,0] op_sel_hi:[0,1]
    v_pk_fma_f32 v[38:39], v[36:37], v[36:37], v[38:39] op_sel:[1,1,0] op_sel_hi:[1,0,1] neg_lo:[1,0,0]
    v_mov_b32 v216, -1
    v_mov_b32 v217, -1
    v_mov_b32 v218, -1
    v_mov_b32 v219, -1
    s_lshl_b32 s74, s5, 13
    buffer_store_dwordx4 v[216:219], v254, s[20:23], s74 offen sc1
    s_lshl_b32 s74, s5, 13
    s_add_u32 s74, s74, 4096
    buffer_store_dwordx4 v[216:219], v254, s[20:23], s74 offen sc1
    s_cmp_lt_u32 s10, 2
    s_cbranch_scc1 L_bk9
    s_cmp_eq_u32 s10, 3
    s_cbranch_scc0 L_t310
    v_readfirstlane_b32 s74, v1
    s_nop 1
    v_mov_b32 v1, s74
L_t310:
    buffer_load_dword a199, v1, s[36:39], 0 offen offset:384
L_bk9:
    v_mov_b32 v82, 1.0
    v_mov_b32_e64 v83, 0
    v_pk_mul_f32 v[86:87], v[82:83], v[80:81] op_sel:[0,0] op_sel_hi:[0,1]
    v_pk_fma_f32 v[86:87], v[82:83], v[80:81], v[86:87] op_sel:[1,1,0] op_sel_hi:[1,0,1] neg_lo:[1,0,0]
    v_cvt_pk_f16_f32 v96, v48, v49
    ds_write_b32 v232, v96 offset:0
    v_pk_mul_f32 v[64:65], v[48:49], v[38:39] op_sel:[0,0] op_sel_hi:[0,1]
    v_pk_fma_f32 v[64:65], v[48:49], v[38:39], v[64:65] op_sel:[1,1,0] op_sel_hi:[1,0,1] neg_lo:[1,0,0]
    v_cvt_pk_f16_f32 v97, v82, v83
    ds_write_b32 v232, v97 offset:11088
    v_pk_mul_f32 v[88:89], v[84:85], v[80:81] op_sel:[0,0] op_sel_hi:[0,1]
    v_pk_fma_f32 v[88:89], v[84:85], v[80:81], v[88:89] op_sel:[1,1,0] op_sel_hi:[1,0,1] neg_lo:[1,0,0]
    v_cvt_pk_f16_f32 v98, v84, v85
    ds_write_b32 v232, v98 offset:19536
    v_pk_mul_f32 v[66:67], v[48:49], v[36:37] op_sel:[0,0] op_sel_hi:[0,1]
    v_pk_fma_f32 v[66:67], v[48:49], v[36:37], v[66:67] op_sel:[1,1,0] op_sel_hi:[1,0,1] neg_lo:[1,0,0]
    v_pk_mul_f32 v[82:83], v[86:87], v[80:81] op_sel:[0,0] op_sel_hi:[0,1]
    v_pk_fma_f32 v[82:83], v[86:87], v[80:81], v[82:83] op_sel:[1,1,0] op_sel_hi:[1,0,1] neg_lo:[1,0,0]
    v_cvt_pk_f16_f32 v99, v86, v87
    ds_write_b32 v232, v99 offset:11616
    v_pk_mul_f32 v[50:51], v[48:49], v[32:33] op_sel:[0,0] op_sel_hi:[0,1]
    v_pk_fma_f32 v[50:51], v[48:49], v[32:33], v[50:51] op_sel:[1,1,0] op_sel_hi:[1,0,1] neg_lo:[1,0,0]
    v_cvt_pk_f16_f32 v100, v64, v65
    ds_write_b32 v232, v100 offset:8448
    v_pk_mul_f32 v[84:85], v[88:89], v[80:81] op_sel:[0,0] op_sel_hi:[0,1]
    v_pk_fma_f32 v[84:85], v[88:89], v[80:81], v[84:85] op_sel:[1,1,0] op_sel_hi:[1,0,1] neg_lo:[1,0,0]
    v_cvt_pk_f16_f32 v101, v88, v89
    ds_write_b32 v232, v101 offset:20064
    v_pk_mul_f32 v[86:87], v[82:83], v[80:81] op_sel:[0,0] op_sel_hi:[0,1]
    v_pk_fma_f32 v[86:87], v[82:83], v[80:81], v[86:87] op_sel:[1,1,0] op_sel_hi:[1,0,1] neg_lo:[1,0,0]
    v_cvt_pk_f16_f32 v102, v66, v67
    ds_write_b32 v232, v102 offset:6336
    v_pk_mul_f32 v[68:69], v[64:65], v[34:35] op_sel:[0,0] op_sel_hi:[0,1]
    v_pk_fma_f32 v[68:69], v[64:65], v[34:35], v[68:69] op_sel:[1,1,0] op_sel_hi:[1,0,1] neg_lo:[1,0,0]
    v_cvt_pk_f16_f32 v103, v82, v83
    ds_write_b32 v232, v103 offset:12144
    v_pk_mul_f32 v[88:89], v[84:85], v[80:81] op_sel:[0,0] op_sel_hi:[0,1]
    v_pk_fma_f32 v[88:89], v[84:85], v[80:81], v[88:89] op_sel:[1,1,0] op_sel_hi:[1,0,1] neg_lo:[1,0,0]
    v_cvt_pk_f16_f32 v96, v84, v85
    ds_write_b32 v232, v96 offset:20592
    v_pk_mul_f32 v[70:71], v[66:67], v[34:35] op_sel:[0,0] op_sel_hi:[0,1]
    v_pk_fma_f32 v[70:71], v[66:67], v[34:35], v[70:71] op_sel:[1,1,0] op_sel_hi:[1,0,1] neg_lo:[1,0,0]
    v_cvt_pk_f16_f32 v97, v50, v51
    ds_write_b32 v232, v97 offset:528
    v_pk_mul_f32 v[82:83], v[86:87], v[80:81] op_sel:[0,0] op_sel_hi:[0,1]
    v_pk_fma_f32 v[82:83], v[86:87], v[80:81], v[82:83] op_sel:[1,1,0] op_sel_hi:[1,0,1] neg_lo:[1,0,0]
    v_cvt_pk_f16_f32 v98, v86, v87
    ds_write_b32 v232, v98 offset:12672
    v_pk_mul_f32 v[52:53], v[50:51], v[32:33] op_sel:[0,0] op_sel_hi:[0,1]
    v_pk_fma_f32 v[52:53], v[50:51], v[32:33], v[52:53] op_sel:[1,1,0] op_sel_hi:[1,0,1] neg_lo:[1,0,0]
    v_pk_mul_f32 v[84:85], v[88:89], v[80:81] op_sel:[0,0] op_sel_hi:[0,1]
    v_pk_fma_f32 v[84:85], v[88:89], v[80:81], v[84:85] op_sel:[1,1,0] op_sel_hi:[1,0,1] neg_lo:[1,0,0]
    v_cvt_pk_f16_f32 v99, v88, v89
    ds_write_b32 v232, v99 offset:21120
    v_pk_mul_f32 v[72:73], v[48:49], v[34:35] op_sel:[0,0] op_sel_hi:[0,1]
    v_pk_fma_f32 v[72:73], v[48:49], v[34:35], v[72:73] op_sel:[1,1,0] op_sel_hi:[1,0,1] neg_lo:[1,0,0]
    v_cvt_pk_f16_f32 v100, v68, v69
    ds_write_b32 v232, v100 offset:8976
    v_pk_mul_f32 v[86:87], v[82:83], v[80:81] op_sel:[0,0] op_sel_hi:[0,1]
    v_pk_fma_f32 v[86:87], v[82:83], v[80:81], v[86:87] op_sel:[1,1,0] op_sel_hi:[1,0,1] neg_lo:[1,0,0]
    v_cvt_pk_f16_f32 v101, v82, v83
    ds_write_b32 v232, v101 offset:13200
    v_pk_mul_f32 v[88:89], v[84:85], v[80:81] op_sel:[0,0] op_sel_hi:[0,1]
    v_pk_fma_f32 v[88:89], v[84:85], v[80:81], v[88:89] op_sel:[1,1,0] op_sel_hi:[1,0,1] neg_lo:[1,0,0]
    v_cvt_pk_f16_f32 v102, v70, v71
    ds_write_b32 v232, v102 offset:7392
    v_pk_mul_f32 v[64:65], v[68:69], v[34:35] op_sel:[0,0] op_sel_hi:[0,1]
    v_pk_fma_f32 v[64:65], v[68:69], v[34:35], v[64:65] op_sel:[1,1,0] op_sel_hi:[1,0,1] neg_lo:[1,0,0]
    v_cvt_pk_f16_f32 v103, v84, v85
    ds_write_b32 v232, v103 offset:21648
    s_lshl_b32 s74, s5, 13
    buffer_store_dwordx4 v[216:219], v254, s[28:31], s74 offen sc1
    s_lshl_b32 s74, s5, 13
    s_add_u32 s74, s74, 4096
    buffer_store_dwordx4 v[216:219], v254, s[28:31], s74 offen sc1
    v_pk_mul_f32 v[82:83], v[86:87], v[80:81] op_sel:[0,0] op_sel_hi:[0,1]
    v_pk_fma_f32 v[82:83], v[86:87], v[80:81], v[82:83] op_sel:[1,1,0] op_sel_hi:[1,0,1] neg_lo:[1,0,0]
    v_cvt_pk_f16_f32 v96, v86, v87
    ds_write_b32 v232, v96 offset:13728
    v_pk_mul_f32 v[84:85], v[88:89], v[80:81] op_sel:[0,0] op_sel_hi:[0,1]
    v_pk_fma_f32 v[84:85], v[88:89], v[80:81], v[84:85] op_sel:[1,1,0] op_sel_hi:[1,0,1] neg_lo:[1,0,0]
    v_cvt_pk_f16_f32 v97, v52, v53
    ds_write_b32 v232, v97 offset:1056
    v_pk_mul_f32 v[54:55], v[52:53], v[32:33] op_sel:[0,0] op_sel_hi:[0,1]
    v_pk_fma_f32 v[54:55], v[52:53], v[32:33], v[54:55] op_sel:[1,1,0] op_sel_hi:[1,0,1] neg_lo:[1,0,0]
    v_cvt_pk_f16_f32 v98, v88, v89
    ds_write_b32 v232, v98 offset:22176
    v_pk_mul_f32 v[86:87], v[82:83], v[80:81] op_sel:[0,0] op_sel_hi:[0,1]
    v_pk_fma_f32 v[86:87], v[82:83], v[80:81], v[86:87] op_sel:[1,1,0] op_sel_hi:[1,0,1] neg_lo:[1,0,0]
    v_cvt_pk_f16_f32 v99, v82, v83
    ds_write_b32 v232, v99 offset:14256
    v_pk_mul_f32 v[74:75], v[52:53], v[34:35] op_sel:[0,0] op_sel_hi:[0,1]
    v_pk_fma_f32 v[74:75], v[52:53], v[34:35], v[74:75] op_sel:[1,1,0] op_sel_hi:[1,0,1] neg_lo:[1,0,0]
    v_cvt_pk_f16_f32 v100, v72, v73
    ds_write_b32 v232, v100 offset:4224
    v_pk_mul_f32 v[88:89], v[84:85], v[80:81] op_sel:[0,0] op_sel_hi:[0,1]
    v_pk_fma_f32 v[88:89], v[84:85], v[80:81], v[88:89] op_sel:[1,1,0] op_sel_hi:[1,0,1] neg_lo:[1,0,0]
    v_cvt_pk_f16_f32 v101, v84, v85
    ds_write_b32 v232, v101 offset:22704
    v_pk_mul_f32 v[82:83], v[86:87], v[80:81] op_sel:[0,0] op_sel_hi:[0,1]
    v_pk_fma_f32 v[82:83], v[86:87], v[80:81], v[82:83] op_sel:[1,1,0] op_sel_hi:[1,0,1] neg_lo:[1,0,0]
    v_cvt_pk_f16_f32 v102, v64, v65
    ds_write_b32 v232, v102 offset:9504
    v_pk_mul_f32 v[68:69], v[64:65], v[34:35] op_sel:[0,0] op_sel_hi:[0,1]
    v_pk_fma_f32 v[68:69], v[64:65], v[34:35], v[68:69] op_sel:[1,1,0] op_sel_hi:[1,0,1] neg_lo:[1,0,0]
    v_cvt_pk_f16_f32 v103, v86, v87
    ds_write_b32 v232, v103 offset:14784
    v_pk_mul_f32 v[84:85], v[88:89], v[80:81] op_sel:[0,0] op_sel_hi:[0,1]
    v_pk_fma_f32 v[84:85], v[88:89], v[80:81], v[84:85] op_sel:[1,1,0] op_sel_hi:[1,0,1] neg_lo:[1,0,0]
    v_cvt_pk_f16_f32 v96, v54, v55
    ds_write_b32 v232, v96 offset:1584
    v_pk_mul_f32 v[56:57], v[54:55], v[32:33] op_sel:[0,0] op_sel_hi:[0,1]
    v_pk_fma_f32 v[56:57], v[54:55], v[32:33], v[56:57] op_sel:[1,1,0] op_sel_hi:[1,0,1] neg_lo:[1,0,0]
    v_cvt_pk_f16_f32 v97, v88, v89
    ds_write_b32 v232, v97 offset:23232
    v_pk_mul_f32 v[86:87], v[82:83], v[80:81] op_sel:[0,0] op_sel_hi:[0,1]
    v_pk_fma_f32 v[86:87], v[82:83], v[80:81], v[86:87] op_sel:[1,1,0] op_sel_hi:[1,0,1] neg_lo:[1,0,0]
    v_cvt_pk_f16_f32 v98, v82, v83
    ds_write_b32 v232, v98 offset:15312
    v_pk_mul_f32 v[88:89], v[84:85], v[80:81] op_sel:[0,0] op_sel_hi:[0,1]
    v_pk_fma_f32 v[88:89], v[84:85], v[80:81], v[88:89] op_sel:[1,1,0] op_sel_hi:[1,0,1] neg_lo:[1,0,0]
    v_cvt_pk_f16_f32 v99, v74, v75
    ds_write_b32 v232, v99 offset:4752
    v_cvt_pk_f16_f32 v100, v68, v69
    ds_write_b32 v232, v100 offset:10032
    v_pk_mul_f32 v[64:65], v[68:69], v[34:35] op_sel:[0,0] op_sel_hi:[0,1]
    v_pk_fma_f32 v[64:65], v[68:69], v[34:35], v[64:65] op_sel:[1,1,0] op_sel_hi:[1,0,1] neg_lo:[1,0,0]
    v_cvt_pk_f16_f32 v101, v84, v85
    ds_write_b32 v232, v101 offset:23760
    v_pk_mul_f32 v[82:83], v[86:87], v[80:81] op_sel:[0,0] op_sel_hi:[0,1]
    v_pk_fma_f32 v[82:83], v[86:87], v[80:81], v[82:83] op_sel:[1,1,0] op_sel_hi:[1,0,1] neg_lo:[1,0,0]
    v_cvt_pk_f16_f32 v102, v86, v87
    ds_write_b32 v232, v102 offset:15840
    v_pk_mul_f32 v[84:85], v[88:89], v[80:81] op_sel:[0,0] op_sel_hi:[0,1]
    v_pk_fma_f32 v[84:85], v[88:89], v[80:81], v[84:85] op_sel:[1,1,0] op_sel_hi:[1,0,1] neg_lo:[1,0,0]
    v_cvt_pk_f16_f32 v103, v56, v57
    ds_write_b32 v232, v103 offset:2112
    v_pk_mul_f32 v[58:59], v[56:57], v[32:33] op_sel:[0,0] op_sel_hi:[0,1]
    v_pk_fma_f32 v[58:59], v[56:57], v[32:33], v[58:59] op_sel:[1,1,0] op_sel_hi:[1,0,1] neg_lo:[1,0,0]
    v_cvt_pk_f16_f32 v96, v88, v89
    ds_write_b32 v232, v96 offset:24288
    v_pk_mul_f32 v[86:87], v[82:83], v[80:81] op_sel:[0,0] op_sel_hi:[0,1]
    v_pk_fma_f32 v[86:87], v[82:83], v[80:81], v[86:87] op_sel:[1,1,0] op_sel_hi:[1,0,1] neg_lo:[1,0,0]
    v_cvt_pk_f16_f32 v97, v82, v83
    ds_write_b32 v232, v97 offset:16368
    v_pk_mul_f32 v[66:67], v[56:57], v[36:37] op_sel:[0,0] op_sel_hi:[0,1]
    v_pk_fma_f32 v[66:67], v[56:57], v[36:37], v[66:67] op_sel:[1,1,0] op_sel_hi:[1,0,1] neg_lo:[1,0,0]
    v_pk_mul_f32 v[88:89], v[84:85], v[80:81] op_sel:[0,0] op_sel_hi:[0,1]
    v_pk_fma_f32 v[88:89], v[84:85], v[80:81], v[88:89] op_sel:[1,1,0] op_sel_hi:[1,0,1] neg_lo:[1,0,0]
    v_cvt_pk_f16_f32 v98, v84, v85
    ds_write_b32 v232, v98 offset:24816
    v_pk_mul_f32 v[72:73], v[56:57], v[34:35] op_sel:[0,0] op_sel_hi:[0,1]
    v_pk_fma_f32 v[72:73], v[56:57], v[34:35], v[72:73] op_sel:[1,1,0] op_sel_hi:[1,0,1] neg_lo:[1,0,0]
    v_cvt_pk_f16_f32 v99, v64, v65
    ds_write_b32 v232, v99 offset:10560
    v_pk_mul_f32 v[82:83], v[86:87], v[80:81] op_sel:[0,0] op_sel_hi:[0,1]
    v_pk_fma_f32 v[82:83], v[86:87], v[80:81], v[82:83] op_sel:[1,1,0] op_sel_hi:[1,0,1] neg_lo:[1,0,0]
    v_cvt_pk_f16_f32 v100, v86, v87
    ds_write_b32 v232, v100 offset:16896
    v_pk_mul_f32 v[84:85], v[88:89], v[80:81] op_sel:[0,0] op_sel_hi:[0,1]
    v_pk_fma_f32 v[84:85], v[88:89], v[80:81], v[84:85] op_sel:[1,1,0] op_sel_hi:[1,0,1] neg_lo:[1,0,0]
    v_cvt_pk_f16_f32 v101, v58, v59
    ds_write_b32 v232, v101 offset:2640
    v_pk_mul_f32 v[60:61], v[58:59], v[32:33] op_sel:[0,0] op_sel_hi:[0,1]
    v_pk_fma_f32 v[60:61], v[58:59], v[32:33], v[60:61] op_sel:[1,1,0] op_sel_hi:[1,0,1] neg_lo:[1,0,0]
    v_cvt_pk_f16_f32 v102, v88, v89
    ds_write_b32 v232, v102 offset:25344
    v_pk_mul_f32 v[86:87], v[82:83], v[80:81] op_sel:[0,0] op_sel_hi:[0,1]
    v_pk_fma_f32 v[86:87], v[82:83], v[80:81], v[86:87] op_sel:[1,1,0] op_sel_hi:[1,0,1] neg_lo:[1,0,0]
    v_cvt_pk_f16_f32 v103, v66, v67
    ds_write_b32 v232, v103 offset:6864
    v_pk_mul_f32 v[70:71], v[66:67], v[34:35] op_sel:[0,0] op_sel_hi:[0,1]
    v_pk_fma_f32 v[70:71], v[66:67], v[34:35], v[70:71] op_sel:[1,1,0] op_sel_hi:[1,0,1] neg_lo:[1,0,0]
    v_cvt_pk_f16_f32 v96, v82, v83
    ds_write_b32 v232, v96 offset:17424
    v_pk_mul_f32 v[88:89], v[84:85], v[80:81] op_sel:[0,0] op_sel_hi:[0,1]
    v_pk_fma_f32 v[88:89], v[84:85], v[80:81], v[88:89] op_sel:[1,1,0] op_sel_hi:[1,0,1] neg_lo:[1,0,0]
    v_cvt_pk_f16_f32 v97, v84, v85
    ds_write_b32 v232, v97 offset:25872
    v_pk_mul_f32 v[82:83], v[86:87], v[80:81] op_sel:[0,0] op_sel_hi:[0,1]
    v_pk_fma_f32 v[82:83], v[86:87], v[80:81], v[82:83] op_sel:[1,1,0] op_sel_hi:[1,0,1] neg_lo:[1,0,0]
    v_cvt_pk_f16_f32 v98, v72, v73
    ds_write_b32 v232, v98 offset:5280
    v_cvt_pk_f16_f32 v99, v60, v61
    ds_write_b32 v232, v99 offset:3168
    v_pk_mul_f32 v[62:63], v[60:61], v[32:33] op_sel:[0,0] op_sel_hi:[0,1]
    v_pk_fma_f32 v[62:63], v[60:61], v[32:33], v[62:63] op_sel:[1,1,0] op_sel_hi:[1,0,1] neg_lo:[1,0,0]
    v_cvt_pk_f16_f32 v100, v86, v87
    ds_write_b32 v232, v100 offset:17952
    v_pk_mul_f32 v[84:85], v[88:89], v[80:81] op_sel:[0,0] op_sel_hi:[0,1]
    v_pk_fma_f32 v[84:85], v[88:89], v[80:81], v[84:85] op_sel:[1,1,0] op_sel_hi:[1,0,1] neg_lo:[1,0,0]
    v_cvt_pk_f16_f32 v101, v88, v89
    ds_write_b32 v232, v101 offset:26400
    v_pk_mul_f32 v[74:75], v[60:61], v[34:35] op_sel:[0,0] op_sel_hi:[0,1]
    v_pk_fma_f32 v[74:75], v[60:61], v[34:35], v[74:75] op_sel:[1,1,0] op_sel_hi:[1,0,1] neg_lo:[1,0,0]
    v_cvt_pk_f16_f32 v102, v70, v71
    ds_write_b32 v232, v102 offset:7920
    v_pk_mul_f32 v[86:87], v[82:83], v[80:81] op_sel:[0,0] op_sel_hi:[0,1]
    v_pk_fma_f32 v[86:87], v[82:83], v[80:81], v[86:87] op_sel:[1,1,0] op_sel_hi:[1,0,1] neg_lo:[1,0,0]
    v_cvt_pk_f16_f32 v103, v82, v83
    ds_write_b32 v232, v103 offset:18480
    v_pk_mul_f32 v[88:89], v[84:85], v[80:81] op_sel:[0,0] op_sel_hi:[0,1]
    v_pk_fma_f32 v[88:89], v[84:85], v[80:81], v[88:89] op_sel:[1,1,0] op_sel_hi:[1,0,1] neg_lo:[1,0,0]
    v_cvt_pk_f16_f32 v96, v62, v63
    ds_write_b32 v232, v96 offset:3696
    v_cvt_pk_f16_f32 v97, v84, v85
    ds_write_b32 v232, v97 offset:26928
    v_cvt_pk_f16_f32 v98, v86, v87
    ds_write_b32 v232, v98 offset:19008
    v_cvt_pk_f16_f32 v99, v74, v75
    ds_write_b32 v232, v99 offset:5808
    v_cvt_pk_f16_f32 v100, v88, v89
    ds_write_b32 v232, v100 offset:27456
    s_lshr_b32 s63, s10, 1
    s_mul_i32 s63, s63, 5888
    s_add_u32 s63, s63, 55968
    s_cmp_lg_u32 s10, 0
    s_cbranch_scc1 L_pb011
    v_and_b32 v98, 3, v2
    v_lshlrev_b32_e64 v98, 6, v98
    global_load_dword v99, v98, s[8:9] sc1
L_pb011:
    s_lshl_b32 s74, s55, 16
    s_lshl_b32 s75, s10, 13
    s_add_u32 s74, s74, s75
    s_lshl_b32 s75, s54, 10
    s_add_u32 s74, s74, s75
    v_lshlrev_b32 v220, 4, v2
    buffer_store_dwordx4 v[216:219], v220, s[32:35], s74 offen sc1
    s_lshl_b32 s74, s55, 16
    s_lshl_b32 s75, s10, 13
    s_add_u32 s74, s74, s75
    s_lshl_b32 s75, s54, 10
    s_add_u32 s74, s74, s75
    s_add_u32 s74, s74, 32768
    v_lshlrev_b32 v220, 4, v2
    buffer_store_dwordx4 v[216:219], v220, s[32:35], s74 offen sc1
    v_mov_b32 v18, 0
    v_mov_b32 v101, s63
    ds_write_b16 v101, v18 offset:4632
    s_waitcnt lgkmcnt(0)
    s_barrier
    ds_read_b128 v[128:131], v233 offset:0
    ds_read_b128 v[132:135], v234 offset:0
    ds_read_b128 v[136:139], v234 offset:8448
    ds_read_b128 v[140:143], v233 offset:64
    ds_read_b128 v[144:147], v234 offset:64
    ds_read_b128 v[148:151], v234 offset:8512
    ds_read_b128 v[152:155], v233 offset:128
    ds_read_b128 v[156:159], v234 offset:128
    ds_read_b128 v[160:163], v234 offset:8576
    ds_read_b128 v[164:167], v233 offset:192
    ds_read_b128 v[168:171], v234 offset:192
    ds_read_b128 v[172:175], v234 offset:8640
    s_waitcnt lgkmcnt(9)
    v_mfma_f32_16x16x32_f16 v[20:23], v[128:131], v[132:135], 0
    v_mfma_f32_16x16x32_f16 v[24:27], v[128:131], v[136:139], 0
    ds_read_b128 v[176:179], v233 offset:256
    ds_read_b128 v[180:183], v234 offset:256
    ds_read_b128 v[184:187], v234 offset:8704
    s_waitcnt lgkmcnt(9)
    v_mfma_f32_16x16x32_f16 v[20:23], v[140:143], v[144:147], v[20:23]
    v_mfma_f32_16x16x32_f16 v[24:27], v[140:143], v[148:151], v[24:27]
    ds_read_b128 v[188:191], v233 offset:320
    ds_read_b128 v[192:195], v234 offset:320
    ds_read_b128 v[196:199], v234 offset:8768
    s_waitcnt lgkmcnt(9)
    v_mfma_f32_16x16x32_f16 v[20:23], v[152:155], v[156:159], v[20:23]
    v_mfma_f32_16x16x32_f16 v[24:27], v[152:155], v[160:163], v[24:27]
    ds_read_b128 v[200:203], v233 offset:384
    ds_read_b128 v[204:207], v234 offset:384
    ds_read_b128 v[208:211], v234 offset:8832
    s_waitcnt lgkmcnt(9)
    v_mfma_f32_16x16x32_f16 v[20:23], v[164:167], v[168:171], v[20:23]
    v_mfma_f32_16x16x32_f16 v[24:27], v[164:167], v[172:175], v[24:27]
    ds_read_b128 v[212:215], v233 offset:448
    ds_read_b128 v[216:219], v234 offset:448
    ds_read_b128 v[220:223], v234 offset:8896
    s_waitcnt lgkmcnt(9)
    v_mfma_f32_16x16x32_f16 v[20:23], v[176:179], v[180:183], v[20:23]
    v_mfma_f32_16x16x32_f16 v[24:27], v[176:179], v[184:187], v[24:27]
    s_waitcnt lgkmcnt(6)
    v_mfma_f32_16x16x32_f16 v[20:23], v[188:191], v[192:195], v[20:23]
    v_mfma_f32_16x16x32_f16 v[24:27], v[188:191], v[196:199], v[24:27]
    s_waitcnt lgkmcnt(3)
    v_mfma_f32_16x16x32_f16 v[20:23], v[200:203], v[204:207], v[20:23]
    v_mfma_f32_16x16x32_f16 v[24:27], v[200:203], v[208:211], v[24:27]
    s_waitcnt lgkmcnt(0)
    v_mfma_f32_16x16x32_f16 v[20:23], v[212:215], v[216:219], v[20:23]
    v_mfma_f32_16x16x32_f16 v[24:27], v[212:215], v[220:223], v[24:27]
    s_nop 6
    s_nop 0
    v_cvt_pk_f16_f32 v28, v20, v21
    v_cvt_pk_f16_f32 v29, v22, v23
    ds_write_b16 v235, v28 offset:0
    ds_write_b16_d16_hi v236, v28 offset:0
    ds_write_b16 v237, v29 offset:0
    ds_write_b16_d16_hi v238, v29 offset:0
    v_cvt_pk_f16_f32 v30, v24, v25
    v_cvt_pk_f16_f32 v31, v26, v27
    ds_write_b16 v235, v30 offset:288
    ds_write_b16_d16_hi v236, v30 offset:288
    ds_write_b16 v237, v31 offset:288
    ds_write_b16_d16_hi v238, v31 offset:288
    s_cmp_lg_u32 s10, 0
    s_cbranch_scc1 L_pb112
    s_waitcnt vmcnt(2)
    v_cmp_gt_u32 vcc, 64, v99
    s_nop 4
    s_cbranch_vccz L_pb112_ok
    s_mov_b32 s62, 0
    v_and_b32 v13, 3, v2
    v_lshlrev_b32 v13, 6, v13
    v_add_u32 v13, s62, v13
    s_mov_b32 s61, 0
L_poll13:
    global_load_dword v14, v13, s[8:9] sc1
    s_waitcnt vmcnt(0)
    v_cmp_gt_u32 vcc, 64, v14
    s_add_u32 s61, s61, 1
    s_nop 3
    s_cbranch_vccz L_poll13_done
    s_cmp_lt_u32 s61, 0x40000
    s_cbranch_scc1 L_poll13
L_poll13_done:
L_pb112_ok:
    v_lshrrev_b32 v4, 1, v2
    v_lshlrev_b32 v4, 13, v4
    v_and_b32 v5, 1, v2
    v_lshl_add_u32 v4, v5, 4, v4
    s_lshl_b32 s61, s11, 4
    buffer_load_dwordx4 a[0:3], v4, s[16:19], s61 offen sc1
    s_nop 0
    s_add_u32 s61, s61, 262144
    buffer_load_dwordx4 a[4:7], v4, s[16:19], s61 offen sc1
    s_add_u32 s61, s61, 262144
    buffer_load_dwordx4 a[8:11], v4, s[16:19], s61 offen sc1
    s_add_u32 s61, s61, 262144
    buffer_load_dwordx4 a[12:15], v4, s[16:19], s61 offen sc1
    s_add_u32 s61, s61, 262144
    buffer_load_dwordx4 a[16:19], v4, s[16:19], s61 offen sc1
    s_add_u32 s61, s61, 262144
    buffer_load_dwordx4 a[20:23], v4, s[16:19], s61 offen sc1
    s_add_u32 s61, s61, 262144
    buffer_load_dwordx4 a[24:27], v4, s[16:19], s61 offen sc1
    s_add_u32 s61, s61, 262144
    buffer_load_dwordx4 a[28:31], v4, s[16:19], s61 offen sc1
L_pb112:
    s_waitcnt lgkmcnt(0)
    s_barrier
    ds_read_u16 v128, v104
    ds_read_u16 v129, v105
    ds_read_u16 v130, v106
    ds_read_u16 v131, v107
    ds_read_u16 v132, v108
    ds_read_u16 v133, v109
    ds_read_u16 v134, v110
    ds_read_u16 v135, v111
    ds_read_u16 v136, v112
    ds_read_u16 v137, v113
    ds_read_u16 v138, v114
    ds_read_u16 v139, v115
    ds_read_u16 v140, v116
    ds_read_u16 v141, v117
    ds_read_u16 v142, v118
    ds_read_u16 v143, v119
    ds_read_u16 v144, v120
    ds_read_u16 v145, v121
    ds_read_u16 v146, v122
    v_mov_b32 v40, 0
    v_mov_b32 v41, 0
    v_mov_b32 v42, 0
    v_mov_b32 v43, 0
    v_lshlrev_b32_e64 v5, 4, v0
    v_cmp_gt_u32 vcc, 155, v0
    s_nop 2
    s_and_saveexec_b64 s[62:63], vcc
    v_add_u32 v44, 33280, v5
    ds_write_b128 v44, v[40:43]
    ds_write_b128 v44, v[40:43] offset:7600
    s_mov_b64 exec, s[62:63]
    v_lshrrev_b32 v44, 2, v0
    v_mul_u32_u24 v44, 4160, v44
    v_and_b32_e64 v45, 3, v0
    v_lshl_add_u32 v44, v45, 4, v44
    v_add_u32 v44, 4096, v44
    v_cmp_gt_u32 vcc, 32, v0
    s_nop 2
    s_and_saveexec_b64 s[62:63], vcc
    ds_write_b128 v44, v[40:43]
    s_mov_b64 exec, s[62:63]
    s_waitcnt lgkmcnt(0)
    s_nop 0
    v_lshl_or_b32 v161, v129, 16, v128
    v_lshl_or_b32 v162, v131, 16, v130
    v_lshl_or_b32 v163, v133, 16, v132
    v_lshl_or_b32 v164, v135, 16, v134
    v_lshl_or_b32 v165, v137, 16, v136
    v_lshl_or_b32 v166, v139, 16, v138
    v_lshl_or_b32 v167, v141, 16, v140
    v_lshl_or_b32 v168, v143, 16, v142
    v_lshl_or_b32 v169, v145, 16, v144
    v_mov_b32 v152, v161
    v_mov_b32 v153, v162
    v_mov_b32 v154, v163
    v_mov_b32 v155, v164
    v_mov_b32 v156, v165
    v_mov_b32 v157, v166
    v_mov_b32 v158, v167
    v_mov_b32 v159, v168
    v_lshl_or_b32 v181, v130, 16, v129
    v_lshl_or_b32 v182, v132, 16, v131
    v_lshl_or_b32 v183, v134, 16, v133
    v_lshl_or_b32 v184, v136, 16, v135
    v_lshl_or_b32 v185, v138, 16, v137
    v_lshl_or_b32 v186, v140, 16, v139
    v_lshl_or_b32 v187, v142, 16, v141
    v_lshl_or_b32 v188, v144, 16, v143
    v_lshl_or_b32 v189, v146, 16, v145
    v_mov_b32 v172, v181
    v_mov_b32 v173, v182
    v_mov_b32 v174, v183
    v_mov_b32 v175, v184
    v_mov_b32 v176, v185
    v_mov_b32 v177, v186
    v_mov_b32 v178, v187
    v_mov_b32 v179, v188
    ds_write_b128 v239, v[152:155] offset:0
    ds_write_b128 v239, v[156:159] offset:16
    ds_write_b128 v239, v[172:175] offset:4160
    ds_write_b128 v239, v[176:179] offset:4176
    ds_write_b128 v239, v[162:165] offset:8320
    ds_write_b128 v239, v[166:169] offset:8336
    ds_write_b128 v239, v[182:185] offset:12480
    ds_write_b128 v239, v[186:189] offset:12496
    s_mul_i32 s59, s10, 20480
    s_add_u32 s59, s59, 76960
    s_lshr_b32 s60, s10, 1
    s_lshl_b32 s60, s60, 6
    v_xor_b32 v246, s60, v241
    v_xor_b32 v247, 64, v246
    v_add_u32 v246, s59, v246
    v_add_u32 v247, s59, v247
    s_mul_i32 s76, s10, 1835008
    s_lshl_b32 s60, s55, 7
    s_add_u32 s76, s76, s60
    s_add_u32 s77, s76, 28672
    s_cmp_lg_u32 s10, 0
    s_cbranch_scc1 L_cw15
    v_lshrrev_b32_e64 v5, 3, v2
    v_mul_u32_u24 v5, 80, v5
    v_bfe_u32 v6, v2, 1, 2
    v_lshl_add_u32 v5, v6, 4, v5
    v_and_b32_e64 v6, 1, v2
    v_mul_u32_u24 v6, 7600, v6
    v_add_u32_e64 v5, v5, v6
    v_add_u32 v5, 35760, v5
    s_waitcnt vmcnt(7)
    ds_write_b128 v5, a[0:3] offset:0
    s_waitcnt vmcnt(6)
    ds_write_b128 v5, a[4:7] offset:640
    s_waitcnt vmcnt(5)
    ds_write_b128 v5, a[8:11] offset:1280
    s_waitcnt vmcnt(4)
    ds_write_b128 v5, a[12:15] offset:1920
    s_waitcnt vmcnt(3)
    ds_write_b128 v5, a[16:19] offset:2560
    s_waitcnt vmcnt(2)
    ds_write_b128 v5, a[20:23] offset:3200
    s_waitcnt vmcnt(1)
    ds_write_b128 v5, a[24:27] offset:3840
    s_waitcnt vmcnt(0)
    ds_write_b128 v5, a[28:31] offset:4480
    s_branch L_cw14
L_cw15:
    s_cmp_lg_u32 s10, 1
    s_cbranch_scc1 L_cw14
    s_waitcnt vmcnt(0)
L_cw14:
    s_lshr_b32 s60, s10, 1
    s_and_b32 s61, s10, 1
    v_and_b32 v52, 31, v2
    v_lshrrev_b32 v53, 5, v2
    v_mov_b32 v54, v248
    v_mov_b32 v55, v249
    s_cmp_lt_u32 s10, 2
    s_cbranch_scc1 L_ph16
    s_waitcnt vmcnt(0)
L_ph16:
    s_waitcnt lgkmcnt(0)
    s_barrier
    s_cmp_lg_u32 s10, 0
    s_cbranch_scc1 L_pa17
    s_and_b32 s62, s2, 7
    s_lshl_b32 s62, s62, 7
    s_add_u32 s62, s62, 12583936
    v_mov_b32 v13, s62
    v_mov_b32 v14, 1
    s_mov_b64 s[62:63], exec
    s_mov_b64 exec, 1
    global_atomic_add v13, v14, s[6:7] sc1
    s_mov_b64 exec, s[62:63]
L_pa17:
    s_lshl_b32 s62, s61, 5
    v_add_u32 v59, s62, v52
    v_mul_u32_u24 v60, 80, v59
    v_lshl_add_u32 v60, v53, 3, v60
    s_mul_i32 s62, s60, 7600
    s_add_u32 s62, s62, 35760
    v_add_u32_e64 v60, s62, v60
    ds_read_b64 v[160:161], v60 offset:0
    ds_read_b64 v[162:163], v60 offset:16
    ds_read_b64 v[164:165], v60 offset:32
    ds_read_b64 v[166:167], v60 offset:48
    ds_read_b64 v[96:97], v54 offset:3968
    ds_read_b64 v[98:99], v54 offset:3976
    ds_read_b128 v[112:115], v55 offset:2400
    ds_read_b128 v[120:123], v55 offset:4960
    ds_read_b64 v[100:101], v54 offset:4000
    ds_read_b64 v[102:103], v54 offset:4008
    ds_read_b128 v[116:119], v55 offset:2432
    ds_read_b128 v[124:127], v55 offset:4992
    ds_read_b64 v[104:105], v54 offset:1920
    ds_read_b64 v[106:107], v54 offset:1928
    ds_read_b64 v[108:109], v54 offset:1952
    ds_read_b64 v[110:111], v54 offset:1960
    s_waitcnt lgkmcnt(9)
    v_mfma_f32_32x32x16_f16 v[64:79], v[96:99], v[112:115], 0
    ds_read_b64 v[128:129], v54 offset:3840
    ds_read_b64 v[130:131], v54 offset:3848
    s_waitcnt lgkmcnt(10)
    v_mfma_f32_32x32x16_f16 v[80:95], v[96:99], v[120:123], 0
    ds_read_b128 v[144:147], v55 offset:2240
    ds_read_b128 v[152:155], v55 offset:4800
    s_add_u32 m0, s59, 0
    s_nop 0
    buffer_load_dwordx4 v240, s[36:39], s76 offen lds
    s_add_u32 s76, s76, 57344
    s_waitcnt lgkmcnt(9)
    v_mfma_f32_32x32x16_f16 v[64:79], v[100:103], v[116:119], v[64:79]
    ds_read_b64 v[132:133], v54 offset:3872
    ds_read_b64 v[134:135], v54 offset:3880
    s_waitcnt lgkmcnt(10)
    v_mfma_f32_32x32x16_f16 v[80:95], v[100:103], v[124:127], v[80:95]
    ds_read_b128 v[148:151], v55 offset:2272
    ds_read_b128 v[156:159], v55 offset:4832
    s_waitcnt lgkmcnt(10)
    v_mfma_f32_32x32x16_f16 v[80:95], v[104:107], v[112:115], v[80:95]
    ds_read_b64 v[136:137], v54 offset:1792
    ds_read_b64 v[138:139], v54 offset:1800
    s_waitcnt lgkmcnt(10)
    v_mfma_f32_32x32x16_f16 v[80:95], v[108:111], v[116:119], v[80:95]
    ds_read_b64 v[140:141], v54 offset:1824
    ds_read_b64 v[142:143], v54 offset:1832
    s_waitcnt lgkmcnt(9)
    v_mfma_f32_32x32x16_f16 v[64:79], v[128:131], v[144:147], v[64:79]
    ds_read_b64 v[96:97], v54 offset:3712
    ds_read_b64 v[98:99], v54 offset:3720
    v_cvt_f32_f16 v168, v160
    s_waitcnt lgkmcnt(10)
    v_mfma_f32_32x32x16_f16 v[80:95], v[128:131], v[152:155], v[80:95]
    ds_read_b128 v[112:115], v55 offset:2080
    ds_read_b128 v[120:123], v55 offset:4640
    v_cvt_f32_f16_sdwa v169, v160 dst_sel:DWORD dst_unused:UNUSED_PAD src0_sel:WORD_1
    s_add_u32 m0, s59, 1024
    s_nop 0
    buffer_load_dwordx4 v240, s[36:39], s77 offen lds
    s_add_u32 s77, s77, 57344
    s_waitcnt lgkmcnt(9)
    v_mfma_f32_32x32x16_f16 v[64:79], v[132:135], v[148:151], v[64:79]
    ds_read_b64 v[100:101], v54 offset:3744
    ds_read_b64 v[102:103], v54 offset:3752
    v_cvt_f32_f16 v170, v161
    s_waitcnt lgkmcnt(10)
    v_mfma_f32_32x32x16_f16 v[80:95], v[132:135], v[156:159], v[80:95]
    ds_read_b128 v[116:119], v55 offset:2112
    ds_read_b128 v[124:127], v55 offset:4672
    v_cvt_f32_f16_sdwa v171, v161 dst_sel:DWORD dst_unused:UNUSED_PAD src0_sel:WORD_1
    s_waitcnt lgkmcnt(10)
    v_mfma_f32_32x32x16_f16 v[80:95], v[136:139], v[144:147], v[80:95]
    ds_read_b64 v[104:105], v54 offset:1664
    ds_read_b64 v[106:107], v54 offset:1672
    v_cvt_f32_f16_e64 v172, v162
    s_add_u32 m0, s59, 2048
    s_nop 0
    buffer_load_dwordx4 v240, s[36:39], s76 offen lds
    s_add_u32 s76, s76, 57344
    s_waitcnt lgkmcnt(10)
    v_mfma_f32_32x32x16_f16 v[80:95], v[140:143], v[148:151], v[80:95]
    ds_read_b64 v[108:109], v54 offset:1696
    ds_read_b64 v[110:111], v54 offset:1704
    v_cvt_f32_f16_sdwa v173, v162 dst_sel:DWORD dst_unused:UNUSED_PAD src0_sel:WORD_1
    s_waitcnt lgkmcnt(9)
    v_mfma_f32_32x32x16_f16 v[64:79], v[96:99], v[112:115], v[64:79]
    ds_read_b64 v[128:129], v54 offset:3584
    ds_read_b64 v[130:131], v54 offset:3592
    v_cvt_f32_f16 v174, v163
    s_waitcnt lgkmcnt(10)
    v_mfma_f32_32x32x16_f16 v[80:95], v[96:99], v[120:123], v[80:95]
    ds_read_b128 v[144:147], v55 offset:1920
    ds_read_b128 v[152:155], v55 offset:4480
    v_cvt_f32_f16_sdwa v175, v163 dst_sel:DWORD dst_unused:UNUSED_PAD src0_sel:WORD_1
    s_add_u32 m0, s59, 3072
    s_nop 0
    buffer_load_dwordx4 v240, s[36:39], s77 offen lds
    s_add_u32 s77, s77, 57344
    s_waitcnt lgkmcnt(9)
    v_mfma_f32_32x32x16_f16 v[64:79], v[100:103], v[116:119], v[64:79]
    ds_read_b64 v[132:133], v54 offset:3616
    ds_read_b64 v[134:135], v54 offset:3624
    v_cvt_f32_f16 v176, v164
    s_waitcnt lgkmcnt(10)
    v_mfma_f32_32x32x16_f16 v[80:95], v[100:103], v[124:127], v[80:95]
    ds_read_b128 v[148:151], v55 offset:1952
    ds_read_b128 v[156:159], v55 offset:4512
    v_cvt_f32_f16_sdwa v177, v164 dst_sel:DWORD dst_unused:UNUSED_PAD src0_sel:WORD_1
    s_waitcnt lgkmcnt(10)
    v_mfma_f32_32x32x16_f16 v[80:95], v[104:107], v[112:115], v[80:95]
    ds_read_b64 v[136:137], v54 offset:1536
    ds_read_b64 v[138:139], v54 offset:1544
    v_cvt_f32_f16 v178, v165
    s_waitcnt lgkmcnt(10)
    v_mfma_f32_32x32x16_f16 v[80:95], v[108:111], v[116:119], v[80:95]
    ds_read_b64 v[140:141], v54 offset:1568
    ds_read_b64 v[142:143], v54 offset:1576
    v_cvt_f32_f16_sdwa v179, v165 dst_sel:DWORD dst_unused:UNUSED_PAD src0_sel:WORD_1
    s_waitcnt lgkmcnt(9)
    v_mfma_f32_32x32x16_f16 v[64:79], v[128:131], v[144:147], v[64:79]
    ds_read_b64 v[96:97], v54 offset:3456
    ds_read_b64 v[98:99], v54 offset:3464
    v_cvt_f32_f16 v180, v166
    s_waitcnt lgkmcnt(10)
    v_mfma_f32_32x32x16_f16 v[80:95], v[128:131], v[152:155], v[80:95]
    ds_read_b128 v[112:115], v55 offset:1760
    ds_read_b128 v[120:123], v55 offset:4320
    v_cvt_f32_f16_sdwa v181, v166 dst_sel:DWORD dst_unused:UNUSED_PAD src0_sel:WORD_1
    s_add_u32 m0, s59, 4096
    s_nop 0
    buffer_load_dwordx4 v240, s[36:39], s76 offen lds
    s_add_u32 s76, s76, 57344
    s_waitcnt lgkmcnt(9)
    v_mfma_f32_32x32x16_f16 v[64:79], v[132:135], v[148:151], v[64:79]
    ds_read_b64 v[100:101], v54 offset:3488
    ds_read_b64 v[102:103], v54 offset:3496
    v_cvt_f32_f16 v182, v167
    s_waitcnt lgkmcnt(10)
    v_mfma_f32_32x32x16_f16 v[80:95], v[132:135], v[156:159], v[80:95]
    ds_read_b128 v[116:119], v55 offset:1792
    ds_read_b128 v[124:127], v55 offset:4352
    v_cvt_f32_f16_sdwa v183, v167 dst_sel:DWORD dst_unused:UNUSED_PAD src0_sel:WORD_1
    s_waitcnt lgkmcnt(10)
    v_mfma_f32_32x32x16_f16 v[80:95], v[136:139], v[144:147], v[80:95]
    ds_read_b64 v[104:105], v54 offset:1408
    ds_read_b64 v[106:107], v54 offset:1416
    v_mul_f32 v168, s53, v168
    s_waitcnt lgkmcnt(10)
    v_mfma_f32_32x32x16_f16 v[80:95], v[140:143], v[148:151], v[80:95]
    ds_read_b64 v[108:109], v54 offset:1440
    ds_read_b64 v[110:111], v54 offset:1448
    v_mul_f32 v169, s53, v169
    s_waitcnt lgkmcnt(9)
    v_mfma_f32_32x32x16_f16 v[64:79], v[96:99], v[112:115], v[64:79]
    ds_read_b64 v[128:129], v54 offset:3328
    ds_read_b64 v[130:131], v54 offset:3336
    v_mul_f32 v170, s53, v170
    s_waitcnt lgkmcnt(10)
    v_mfma_f32_32x32x16_f16 v[80:95], v[96:99], v[120:123], v[80:95]
    ds_read_b128 v[144:147], v55 offset:1600
    ds_read_b128 v[152:155], v55 offset:4160
    v_mul_f32_e64 v171, s53, v171
    s_add_u32 m0, s59, 5120
    s_nop 0
    buffer_load_dwordx4 v240, s[36:39], s77 offen lds
    s_add_u32 s77, s77, 57344
    s_waitcnt lgkmcnt(9)
    v_mfma_f32_32x32x16_f16 v[64:79], v[100:103], v[116:119], v[64:79]
    ds_read_b64 v[132:133], v54 offset:3360
    ds_read_b64 v[134:135], v54 offset:3368
    v_mul_f32 v172, s53, v172
    s_waitcnt lgkmcnt(10)
    v_mfma_f32_32x32x16_f16 v[80:95], v[100:103], v[124:127], v[80:95]
    ds_read_b128 v[148:151], v55 offset:1632
    ds_read_b128 v[156:159], v55 offset:4192
    v_mul_f32 v173, s53, v173
    s_cmp_lt_u32 s10, 2
    s_cbranch_scc1 L_bk18
    s_and_b32 s74, s2, 7
    s_lshr_b32 s74, s74, 1
    s_lshl_b32 s74, s74, 10
    s_and_b32 s75, s10, 1
    s_lshl_b32 s75, s75, 9
    s_add_u32 s74, s74, s75
    s_lshr_b32 s75, s2, 3
    s_mul_i32 s75, s75, 56
    v_min_u32 v30, 55, v2
    v_add_u32 v30, s75, v30
    v_lshlrev_b32 v30, 12, v30
    v_add_u32_e64 v30, s74, v30
    buffer_load_dword a199, v30, s[40:43], 0 offen offset:0
L_bk18:
    s_waitcnt lgkmcnt(10)
    v_mfma_f32_32x32x16_f16 v[80:95], v[104:107], v[112:115], v[80:95]
    ds_read_b64 v[136:137], v54 offset:1280
    ds_read_b64 v[138:139], v54 offset:1288
    v_mul_f32 v174, s53, v174
    s_waitcnt lgkmcnt(10)
    v_mfma_f32_32x32x16_f16 v[80:95], v[108:111], v[116:119], v[80:95]
    ds_read_b64 v[140:141], v54 offset:1312
    ds_read_b64 v[142:143], v54 offset:1320
    v_mul_f32 v175, s53, v175
    s_waitcnt lgkmcnt(9)
    v_mfma_f32_32x32x16_f16 v[64:79], v[128:131], v[144:147], v[64:79]
    ds_read_b64 v[96:97], v54 offset:3200
    ds_read_b64 v[98:99], v54 offset:3208
    v_mul_f32 v176, s53, v176
    s_waitcnt lgkmcnt(10)
    v_mfma_f32_32x32x16_f16 v[80:95], v[128:131], v[152:155], v[80:95]
    ds_read_b128 v[112:115], v55 offset:1440
    ds_read_b128 v[120:123], v55 offset:4000
    v_mul_f32 v177, s53, v177
    s_add_u32 m0, s59, 6144
    s_nop 0
    buffer_load_dwordx4 v240, s[36:39], s76 offen lds
    s_add_u32 s76, s76, 57344
    s_waitcnt lgkmcnt(9)
    v_mfma_f32_32x32x16_f16 v[64:79], v[132:135], v[148:151], v[64:79]
    ds_read_b64 v[100:101], v54 offset:3232
    ds_read_b64 v[102:103], v54 offset:3240
    v_mul_f32 v178, s53, v178
    s_waitcnt lgkmcnt(10)
    v_mfma_f32_32x32x16_f16 v[80:95], v[132:135], v[156:159], v[80:95]
    ds_read_b128 v[116:119], v55 offset:1472
    ds_read_b128 v[124:127], v55 offset:4032
    v_mul_f32 v179, s53, v179
    s_waitcnt lgkmcnt(10)
    v_mfma_f32_32x32x16_f16 v[80:95], v[136:139], v[144:147], v[80:95]
    ds_read_b64 v[104:105], v54 offset:1152
    ds_read_b64 v[106:107], v54 offset:1160
    v_mul_f32_e64 v180, s53, v180
    s_add_u32 m0, s59, 7168
    s_nop 0
    buffer_load_dwordx4 v240, s[36:39], s77 offen lds
    s_add_u32 s77, s77, 57344
    s_waitcnt lgkmcnt(10)
    v_mfma_f32_32x32x16_f16 v[80:95], v[140:143], v[148:151], v[80:95]
    ds_read_b64 v[108:109], v54 offset:1184
    ds_read_b64 v[110:111], v54 offset:1192
    v_mul_f32 v181, s53, v181
    s_waitcnt lgkmcnt(9)
    v_mfma_f32_32x32x16_f16 v[64:79], v[96:99], v[112:115], v[64:79]
    ds_read_b64 v[128:129], v54 offset:3072
    ds_read_b64 v[130:131], v54 offset:3080
    v_mul_f32 v182, s53, v182
    s_waitcnt lgkmcnt(10)
    v_mfma_f32_32x32x16_f16 v[80:95], v[96:99], v[120:123], v[80:95]
    ds_read_b128 v[144:147], v55 offset:1280
    ds_read_b128 v[152:155], v55 offset:3840
    v_mul_f32_e64 v183, s53, v183
    s_add_u32 m0, s59, 8192
    s_nop 0
    buffer_load_dwordx4 v240, s[36:39], s76 offen lds
    s_add_u32 s76, s76, 57344
    s_waitcnt lgkmcnt(9)
    v_mfma_f32_32x32x16_f16 v[64:79], v[100:103], v[116:119], v[64:79]
    ds_read_b64 v[132:133], v54 offset:3104
    ds_read_b64 v[134:135], v54 offset:3112
    v_cvt_pk_bf16_f32 v184, v168, v169
    s_waitcnt lgkmcnt(10)
    v_mfma_f32_32x32x16_f16 v[80:95], v[100:103], v[124:127], v[80:95]
    ds_read_b128 v[148:151], v55 offset:1312
    ds_read_b128 v[156:159], v55 offset:3872
    v_cvt_pk_bf16_f32 v185, v170, v171
    s_waitcnt lgkmcnt(10)
    v_mfma_f32_32x32x16_f16 v[80:95], v[104:107], v[112:115], v[80:95]
    ds_read_b64 v[136:137], v54 offset:1024
    ds_read_b64 v[138:139], v54 offset:1032
    v_cvt_pk_bf16_f32 v186, v172, v173
    s_waitcnt lgkmcnt(10)
    v_mfma_f32_32x32x16_f16 v[80:95], v[108:111], v[116:119], v[80:95]
    ds_read_b64 v[140:141], v54 offset:1056
    ds_read_b64 v[142:143], v54 offset:1064
    v_cvt_pk_bf16_f32 v187, v174, v175
    s_waitcnt lgkmcnt(9)
    v_mfma_f32_32x32x16_f16 v[64:79], v[128:131], v[144:147], v[64:79]
    ds_read_b64 v[96:97], v54 offset:2944
    ds_read_b64 v[98:99], v54 offset:2952
    v_cvt_pk_bf16_f32 v188, v176, v177
    s_waitcnt lgkmcnt(10)
    v_mfma_f32_32x32x16_f16 v[80:95], v[128:131], v[152:155], v[80:95]
    ds_read_b128 v[112:115], v55 offset:1120
    ds_read_b128 v[120:123], v55 offset:3680
    v_cvt_pk_bf16_f32 v189, v178, v179
    s_add_u32 m0, s59, 9216
    s_nop 0
    buffer_load_dwordx4 v240, s[36:39], s77 offen lds
    s_add_u32 s77, s77, 57344
    s_waitcnt lgkmcnt(9)
    v_mfma_f32_32x32x16_f16 v[64:79], v[132:135], v[148:151], v[64:79]
    ds_read_b64 v[100:101], v54 offset:2976
    ds_read_b64 v[102:103], v54 offset:2984
    v_cvt_pk_bf16_f32 v190, v180, v181
    s_waitcnt lgkmcnt(10)
    v_mfma_f32_32x32x16_f16 v[80:95], v[132:135], v[156:159], v[80:95]
    ds_read_b128 v[116:119], v55 offset:1152
    ds_read_b128 v[124:127], v55 offset:3712
    v_cvt_pk_bf16_f32 v191, v182, v183
    s_cmp_lt_u32 s10, 2
    s_cbranch_scc1 L_bk19
    buffer_load_dword a199, v30, s[40:43], 0 offen offset:128
L_bk19:
    s_waitcnt lgkmcnt(10)
    v_mfma_f32_32x32x16_f16 v[80:95], v[136:139], v[144:147], v[80:95]
    ds_read_b64 v[104:105], v54 offset:896
    ds_read_b64 v[106:107], v54 offset:904
    v_lshlrev_b32 v168, 16, v184
    s_waitcnt lgkmcnt(10)
    v_mfma_f32_32x32x16_f16 v[80:95], v[140:143], v[148:151], v[80:95]
    ds_read_b64 v[108:109], v54 offset:928
    ds_read_b64 v[110:111], v54 offset:936
    v_and_b32 v169, 0xffff0000, v184
    s_waitcnt lgkmcnt(9)
    v_mfma_f32_32x32x16_f16 v[64:79], v[96:99], v[112:115], v[64:79]
    ds_read_b64 v[128:129], v54 offset:2816
    ds_read_b64 v[130:131], v54 offset:2824
    v_lshlrev_b32 v170, 16, v185
    s_waitcnt lgkmcnt(10)
    v_mfma_f32_32x32x16_f16 v[80:95], v[96:99], v[120:123], v[80:95]
    ds_read_b128 v[144:147], v55 offset:960
    ds_read_b128 v[152:155], v55 offset:3520
    v_and_b32 v171, 0xffff0000, v185
    s_add_u32 m0, s59, 10240
    s_nop 0
    buffer_load_dwordx4 v240, s[36:39], s76 offen lds
    s_add_u32 s76, s76, 57344
    s_waitcnt lgkmcnt(9)
    v_mfma_f32_32x32x16_f16 v[64:79], v[100:103], v[116:119], v[64:79]
    ds_read_b64 v[132:133], v54 offset:2848
    ds_read_b64 v[134:135], v54 offset:2856
    v_lshlrev_b32 v172, 16, v186
    s_waitcnt lgkmcnt(10)
    v_mfma_f32_32x32x16_f16 v[80:95], v[100:103], v[124:127], v[80:95]
    ds_read_b128 v[148:151], v55 offset:992
    ds_read_b128 v[156:159], v55 offset:3552
    v_and_b32 v173, 0xffff0000, v186
    s_waitcnt lgkmcnt(10)
    v_mfma_f32_32x32x16_f16 v[80:95], v[104:107], v[112:115], v[80:95]
    ds_read_b64 v[136:137], v54 offset:768
    ds_read_b64 v[138:139], v54 offset:776
    v_lshlrev_b32 v174, 16, v187
    s_waitcnt lgkmcnt(10)
    v_mfma_f32_32x32x16_f16 v[80:95], v[108:111], v[116:119], v[80:95]
    ds_read_b64 v[140:141], v54 offset:800
    ds_read_b64 v[142:143], v54 offset:808
    v_and_b32 v175, 0xffff0000, v187
    s_waitcnt lgkmcnt(9)
    v_mfma_f32_32x32x16_f16 v[64:79], v[128:131], v[144:147], v[64:79]
    ds_read_b64 v[96:97], v54 offset:2688
    ds_read_b64 v[98:99], v54 offset:2696
    v_lshlrev_b32 v176, 16, v188
    s_waitcnt lgkmcnt(10)
    v_mfma_f32_32x32x16_f16 v[80:95], v[128:131], v[152:155], v[80:95]
    ds_read_b128 v[112:115], v55 offset:800
    ds_read_b128 v[120:123], v55 offset:3360
    v_and_b32 v177, 0xffff0000, v188
    s_add_u32 m0, s59, 11264
    s_nop 0
    buffer_load_dwordx4 v240, s[36:39], s77 offen lds
    s_add_u32 s77, s77, 57344
    s_waitcnt lgkmcnt(9)
    v_mfma_f32_32x32x16_f16 v[64:79], v[132:135], v[148:151], v[64:79]
    ds_read_b64 v[100:101], v54 offset:2720
    ds_read_b64 v[102:103], v54 offset:2728
    v_lshlrev_b32 v178, 16, v189
    s_waitcnt lgkmcnt(10)
    v_mfma_f32_32x32x16_f16 v[80:95], v[132:135], v[156:159], v[80:95]
    ds_read_b128 v[116:119], v55 offset:832
    ds_read_b128 v[124:127], v55 offset:3392
    v_and_b32 v179, 0xffff0000, v189
    s_waitcnt lgkmcnt(10)
    v_mfma_f32_32x32x16_f16 v[80:95], v[136:139], v[144:147], v[80:95]
    ds_read_b64 v[104:105], v54 offset:640
    ds_read_b64 v[106:107], v54 offset:648
    v_lshlrev_b32 v180, 16, v190
    s_add_u32 m0, s59, 12288
    s_nop 0
    buffer_load_dwordx4 v240, s[36:39], s76 offen lds
    s_add_u32 s76, s76, 57344
    s_waitcnt lgkmcnt(10)
    v_mfma_f32_32x32x16_f16 v[80:95], v[140:143], v[148:151], v[80:95]
    ds_read_b64 v[108:109], v54 offset:672
    ds_read_b64 v[110:111], v54 offset:680
    v_and_b32 v181, 0xffff0000, v190
    s_waitcnt lgkmcnt(9)
    v_mfma_f32_32x32x16_f16 v[64:79], v[96:99], v[112:115], v[64:79]
    ds_read_b64 v[128:129], v54 offset:2560
    ds_read_b64 v[130:131], v54 offset:2568
    v_lshlrev_b32 v182, 16, v191
    s_waitcnt lgkmcnt(10)
    v_mfma_f32_32x32x16_f16 v[80:95], v[96:99], v[120:123], v[80:95]
    ds_read_b128 v[144:147], v55 offset:640
    ds_read_b128 v[152:155], v55 offset:3200
    v_and_b32 v183, 0xffff0000, v191
    s_add_u32 m0, s59, 13312
    s_nop 0
    buffer_load_dwordx4 v240, s[36:39], s77 offen lds
    s_add_u32 s77, s77, 57344
    s_waitcnt lgkmcnt(9)
    v_mfma_f32_32x32x16_f16 v[64:79], v[100:103], v[116:119], v[64:79]
    ds_read_b64 v[132:133], v54 offset:2592
    ds_read_b64 v[134:135], v54 offset:2600
    s_waitcnt lgkmcnt(10)
    v_mfma_f32_32x32x16_f16 v[80:95], v[100:103], v[124:127], v[80:95]
    ds_read_b128 v[148:151], v55 offset:672
    ds_read_b128 v[156:159], v55 offset:3232
    s_cmp_lt_u32 s10, 2
    s_cbranch_scc1 L_bk20
    buffer_load_dword a199, v30, s[40:43], 0 offen offset:256
L_bk20:
    s_waitcnt lgkmcnt(10)
    v_mfma_f32_32x32x16_f16 v[80:95], v[104:107], v[112:115], v[80:95]
    ds_read_b64 v[136:137], v54 offset:512
    ds_read_b64 v[138:139], v54 offset:520
    s_waitcnt lgkmcnt(10)
    v_mfma_f32_32x32x16_f16 v[80:95], v[108:111], v[116:119], v[80:95]
    ds_read_b64 v[140:141], v54 offset:544
    ds_read_b64 v[142:143], v54 offset:552
    s_waitcnt lgkmcnt(9)
    v_mfma_f32_32x32x16_f16 v[64:79], v[128:131], v[144:147], v[64:79]
    ds_read_b64 v[96:97], v54 offset:2432
    ds_read_b64 v[98:99], v54 offset:2440
    s_waitcnt lgkmcnt(10)
    v_mfma_f32_32x32x16_f16 v[80:95], v[128:131], v[152:155], v[80:95]
    ds_read_b128 v[112:115], v55 offset:480
    ds_read_b128 v[120:123], v55 offset:3040
    s_add_u32 m0, s59, 14336
    s_nop 0
    buffer_load_dwordx4 v240, s[36:39], s76 offen lds
    s_add_u32 s76, s76, 57344
    s_waitcnt lgkmcnt(9)
    v_mfma_f32_32x32x16_f16 v[64:79], v[132:135], v[148:151], v[64:79]
    ds_read_b64 v[100:101], v54 offset:2464
    ds_read_b64 v[102:103], v54 offset:2472
    s_waitcnt lgkmcnt(10)
    v_mfma_f32_32x32x16_f16 v[80:95], v[132:135], v[156:159], v[80:95]
    ds_read_b128 v[116:119], v55 offset:512
    ds_read_b128 v[124:127], v55 offset:3072
    s_waitcnt lgkmcnt(10)
    v_mfma_f32_32x32x16_f16 v[80:95], v[136:139], v[144:147], v[80:95]
    ds_read_b64 v[104:105], v54 offset:384
    ds_read_b64 v[106:107], v54 offset:392
    s_waitcnt lgkmcnt(10)
    v_mfma_f32_32x32x16_f16 v[80:95], v[140:143], v[148:151], v[80:95]
    ds_read_b64 v[108:109], v54 offset:416
    ds_read_b64 v[110:111], v54 offset:424
    s_waitcnt lgkmcnt(9)
    v_mfma_f32_32x32x16_f16 v[64:79], v[96:99], v[112:115], v[64:79]
    ds_read_b64 v[128:129], v54 offset:2304
    ds_read_b64 v[130:131], v54 offset:2312
    s_waitcnt lgkmcnt(10)
    v_mfma_f32_32x32x16_f16 v[80:95], v[96:99], v[120:123], v[80:95]
    ds_read_b128 v[144:147], v55 offset:320
    ds_read_b128 v[152:155], v55 offset:2880
    s_add_u32 m0, s59, 15360
    s_nop 0
    buffer_load_dwordx4 v240, s[36:39], s77 offen lds
    s_add_u32 s77, s77, 57344
    s_waitcnt lgkmcnt(9)
    v_mfma_f32_32x32x16_f16 v[64:79], v[100:103], v[116:119], v[64:79]
    ds_read_b64 v[132:133], v54 offset:2336
    ds_read_b64 v[134:135], v54 offset:2344
    s_waitcnt lgkmcnt(10)
    v_mfma_f32_32x32x16_f16 v[80:95], v[100:103], v[124:127], v[80:95]
    ds_read_b128 v[148:151], v55 offset:352
    ds_read_b128 v[156:159], v55 offset:2912
    s_waitcnt lgkmcnt(10)
    v_mfma_f32_32x32x16_f16 v[80:95], v[104:107], v[112:115], v[80:95]
    ds_read_b64 v[136:137], v54 offset:256
    ds_read_b64 v[138:139], v54 offset:264
    s_waitcnt lgkmcnt(10)
    v_mfma_f32_32x32x16_f16 v[80:95], v[108:111], v[116:119], v[80:95]
    ds_read_b64 v[140:141], v54 offset:288
    ds_read_b64 v[142:143], v54 offset:296
    s_waitcnt lgkmcnt(9)
    v_mfma_f32_32x32x16_f16 v[64:79], v[128:131], v[144:147], v[64:79]
    ds_read_b64 v[96:97], v54 offset:2176
    ds_read_b64 v[98:99], v54 offset:2184
    s_waitcnt lgkmcnt(10)
    v_mfma_f32_32x32x16_f16 v[80:95], v[128:131], v[152:155], v[80:95]
    ds_read_b128 v[112:115], v55 offset:160
    ds_read_b128 v[120:123], v55 offset:2720
    s_add_u32 m0, s59, 16384
    s_nop 0
    buffer_load_dwordx4 v240, s[36:39], s76 offen lds
    s_add_u32 s76, s76, 57344
    s_waitcnt lgkmcnt(9)
    v_mfma_f32_32x32x16_f16 v[64:79], v[132:135], v[148:151], v[64:79]
    ds_read_b64 v[100:101], v54 offset:2208
    ds_read_b64 v[102:103], v54 offset:2216
    s_waitcnt lgkmcnt(10)
    v_mfma_f32_32x32x16_f16 v[80:95], v[132:135], v[156:159], v[80:95]
    ds_read_b128 v[116:119], v55 offset:192
    ds_read_b128 v[124:127], v55 offset:2752
    s_cmp_lt_u32 s10, 2
    s_cbranch_scc1 L_bk21
    buffer_load_dword a199, v30, s[40:43], 0 offen offset:384
L_bk21:
    s_waitcnt lgkmcnt(10)
    v_mfma_f32_32x32x16_f16 v[80:95], v[136:139], v[144:147], v[80:95]
    ds_read_b64 v[104:105], v54 offset:128
    ds_read_b64 v[106:107], v54 offset:136
    s_add_u32 m0, s59, 17408
    s_nop 0
    buffer_load_dwordx4 v240, s[36:39], s77 offen lds
    s_add_u32 s77, s77, 57344
    s_waitcnt lgkmcnt(10)
    v_mfma_f32_32x32x16_f16 v[80:95], v[140:143], v[148:151], v[80:95]
    ds_read_b64 v[108:109], v54 offset:160
    ds_read_b64 v[110:111], v54 offset:168
    s_waitcnt lgkmcnt(9)
    v_mfma_f32_32x32x16_f16 v[64:79], v[96:99], v[112:115], v[64:79]
    ds_read_b64 v[128:129], v54 offset:2048
    ds_read_b64 v[130:131], v54 offset:2056
    s_waitcnt lgkmcnt(10)
    v_mfma_f32_32x32x16_f16 v[80:95], v[96:99], v[120:123], v[80:95]
    ds_read_b128 v[144:147], v55 offset:0
    ds_read_b128 v[152:155], v55 offset:2560
    s_add_u32 m0, s59, 18432
    s_nop 0
    buffer_load_dwordx4 v240, s[36:39], s76 offen lds
    s_add_u32 s76, s76, 57344
    s_waitcnt lgkmcnt(9)
    v_mfma_f32_32x32x16_f16 v[64:79], v[100:103], v[116:119], v[64:79]
    ds_read_b64 v[132:133], v54 offset:2080
    ds_read_b64 v[134:135], v54 offset:2088
    s_waitcnt lgkmcnt(10)
    v_mfma_f32_32x32x16_f16 v[80:95], v[100:103], v[124:127], v[80:95]
    ds_read_b128 v[148:151], v55 offset:32
    ds_read_b128 v[156:159], v55 offset:2592
    s_waitcnt lgkmcnt(10)
    v_mfma_f32_32x32x16_f16 v[80:95], v[104:107], v[112:115], v[80:95]
    ds_read_b64 v[136:137], v54 offset:0
    ds_read_b64 v[138:139], v54 offset:8
    s_waitcnt lgkmcnt(10)
    v_mfma_f32_32x32x16_f16 v[80:95], v[108:111], v[116:119], v[80:95]
    ds_read_b64 v[140:141], v54 offset:32
    ds_read_b64 v[142:143], v54 offset:40
    s_waitcnt lgkmcnt(9)
    v_mfma_f32_32x32x16_f16 v[64:79], v[128:131], v[144:147], v[64:79]
    s_waitcnt lgkmcnt(8)
    v_mfma_f32_32x32x16_f16 v[80:95], v[128:131], v[152:155], v[80:95]
    s_add_u32 m0, s59, 19456
    s_nop 0
    buffer_load_dwordx4 v240, s[36:39], s77 offen lds
    s_add_u32 s77, s77, 57344
    s_waitcnt lgkmcnt(5)
    v_mfma_f32_32x32x16_f16 v[64:79], v[132:135], v[148:151], v[64:79]
    s_waitcnt lgkmcnt(4)
    v_mfma_f32_32x32x16_f16 v[80:95], v[132:135], v[156:159], v[80:95]
    s_waitcnt lgkmcnt(2)
    v_mfma_f32_32x32x16_f16 v[80:95], v[136:139], v[144:147], v[80:95]
    s_waitcnt lgkmcnt(0)
    v_mfma_f32_32x32x16_f16 v[80:95], v[140:143], v[148:151], v[80:95]
    s_cmp_lg_u32 s10, 0
    s_cbranch_scc1 L_pf22
    v_and_b32 v50, 7, v2
    v_lshlrev_b32 v50, 7, v50
    v_add_u32 v50, 12583936, v50
    global_load_dword v51, v50, s[6:7] sc1
L_pf22:
    v_lshlrev_b32_e64 v56, 4, v2
    v_add_u32 v56, 48640, v56
    s_lshl_b32 s62, s10, 12
    v_add_u32 v57, s62, v56
    s_xor_b32 s63, s10, 1
    s_lshl_b32 s63, s63, 12
    v_add_u32 v58, s63, v56
    s_cmp_eq_u32 s61, 0
    s_cbranch_scc0 L_cp23
    s_nop 7
    s_nop 7
    ds_write_b128 v57, v[80:83] offset:0
    ds_write_b128 v57, v[84:87] offset:1024
    ds_write_b128 v57, v[88:91] offset:2048
    ds_write_b128 v57, v[92:95] offset:3072
    s_branch L_cr24
L_cp23:
    s_nop 7
    s_nop 7
    ds_write_b128 v57, v[64:67] offset:0
    ds_write_b128 v57, v[68:71] offset:1024
    ds_write_b128 v57, v[72:75] offset:2048
    ds_write_b128 v57, v[76:79] offset:3072
    v_mov_b32 v64, v80
    v_mov_b32 v65, v81
    v_mov_b32 v66, v82
    v_mov_b32 v67, v83
    v_mov_b32 v68, v84
    v_mov_b32 v69, v85
    v_mov_b32 v70, v86
    v_mov_b32 v71, v87
    v_mov_b32 v72, v88
    v_mov_b32 v73, v89
    v_mov_b32 v74, v90
    v_mov_b32 v75, v91
    v_mov_b32 v76, v92
    v_mov_b32 v77, v93
    v_mov_b32 v78, v94
    v_mov_b32 v79, v95
L_cr24:
    s_waitcnt lgkmcnt(0)
    s_barrier
    ds_read_b128 v[96:99], v58 offset:0
    ds_read_b128 v[100:103], v58 offset:1024
    ds_read_b128 v[104:107], v58 offset:2048
    ds_read_b128 v[108:111], v58 offset:3072
    s_waitcnt lgkmcnt(0)
    s_nop 0
    v_pk_add_f32 v[64:65], v[64:65], v[96:97]
    v_pk_add_f32 v[66:67], v[66:67], v[98:99]
    v_pk_add_f32 v[68:69], v[68:69], v[100:101]
    v_pk_add_f32 v[70:71], v[70:71], v[102:103]
    v_pk_add_f32 v[72:73], v[72:73], v[104:105]
    v_pk_add_f32 v[74:75], v[74:75], v[106:107]
    v_pk_add_f32 v[76:77], v[76:77], v[108:109]
    v_pk_add_f32 v[78:79], v[78:79], v[110:111]
    v_pk_mul_f32 v[64:65], v[64:65], s[52:53] op_sel_hi:[1,0]
    v_pk_mul_f32 v[66:67], v[66:67], s[52:53] op_sel_hi:[1,0]
    v_pk_mul_f32 v[68:69], v[68:69], s[52:53] op_sel_hi:[1,0]
    v_pk_mul_f32 v[70:71], v[70:71], s[52:53] op_sel_hi:[1,0]
    v_pk_mul_f32 v[72:73], v[72:73], s[52:53] op_sel_hi:[1,0]
    v_pk_mul_f32 v[74:75], v[74:75], s[52:53] op_sel_hi:[1,0]
    v_pk_mul_f32 v[76:77], v[76:77], s[52:53] op_sel_hi:[1,0]
    v_pk_mul_f32 v[78:79], v[78:79], s[52:53] op_sel_hi:[1,0]
    v_cvt_pk_bf16_f32 v136, v64, v65
    v_cvt_pk_bf16_f32 v137, v66, v67
    v_cvt_pk_bf16_f32 v138, v68, v69
    v_cvt_pk_bf16_f32 v139, v70, v71
    v_cvt_pk_bf16_f32 v140, v72, v73
    v_cvt_pk_bf16_f32 v141, v74, v75
    v_cvt_pk_bf16_f32 v142, v76, v77
    v_cvt_pk_bf16_f32 v143, v78, v79
    v_lshlrev_b32_e64 v64, 16, v136
    v_and_b32 v65, 0xffff0000, v136
    v_lshlrev_b32_e64 v66, 16, v137
    v_and_b32 v67, 0xffff0000, v137
    v_lshlrev_b32_e64 v68, 16, v138
    v_and_b32 v69, 0xffff0000, v138
    v_lshlrev_b32_e64 v70, 16, v139
    v_and_b32 v71, 0xffff0000, v139
    v_lshlrev_b32_e64 v72, 16, v140
    v_and_b32 v73, 0xffff0000, v140
    v_lshlrev_b32_e64 v74, 16, v141
    v_and_b32 v75, 0xffff0000, v141
    v_lshlrev_b32_e64 v76, 16, v142
    v_and_b32 v77, 0xffff0000, v142
    v_lshlrev_b32_e64 v78, 16, v143
    v_and_b32 v79, 0xffff0000, v143
    v_pk_add_f32 v[64:65], v[64:65], v[168:169]
    v_pk_add_f32 v[66:67], v[66:67], v[170:171]
    v_pk_add_f32 v[68:69], v[68:69], v[172:173]
    v_pk_add_f32 v[70:71], v[70:71], v[174:175]
    v_pk_add_f32 v[72:73], v[72:73], v[176:177]
    v_pk_add_f32 v[74:75], v[74:75], v[178:179]
    v_pk_add_f32 v[76:77], v[76:77], v[180:181]
    v_pk_add_f32 v[78:79], v[78:79], v[182:183]
    v_cvt_pk_bf16_f32 v136, v64, v65
    v_cvt_pk_bf16_f32 v137, v66, v67
    v_cvt_pk_bf16_f32 v138, v68, v69
    v_cvt_pk_bf16_f32 v139, v70, v71
    v_cvt_pk_bf16_f32 v140, v72, v73
    v_cvt_pk_bf16_f32 v141, v74, v75
    v_cvt_pk_bf16_f32 v142, v76, v77
    v_cvt_pk_bf16_f32 v143, v78, v79
    v_permlane32_swap_b32 v136, v138
    v_permlane32_swap_b32 v137, v139
    v_permlane32_swap_b32 v140, v142
    v_permlane32_swap_b32 v141, v143
    v_mul_u32_u24 v61, 144, v59
    v_lshl_add_u32 v61, v53, 5, v61
    s_lshl_b32 s62, s60, 4
    s_add_u32 s62, s62, 16384
    v_add_u32 v61, s62, v61
    ds_write_b128 v61, v[136:139]
    ds_write_b128 v61, v[140:143] offset:64
    v_lshrrev_b32_e64 v62, 3, v0
    v_mul_u32_u24 v62, 144, v62
    v_and_b32_e64 v63, 7, v0
    v_lshl_add_u32 v62, v63, 4, v62
    s_waitcnt lgkmcnt(0)
    s_barrier
    s_cmp_ge_u32 s10, 2
    s_cbranch_scc1 L_yo25
    ds_read_b128 v[96:99], v62 offset:16384
    ds_read_b128 v[100:103], v62 offset:18688
    ds_read_b128 v[104:107], v62 offset:20992
    ds_read_b128 v[108:111], v62 offset:23296
    s_lshl_b32 s62, s5, 13
    s_waitcnt lgkmcnt(3)
    buffer_store_dwordx4 v[96:99], v254, s[20:23], s62 offen sc1
    s_add_u32 s62, s62, 2048
    s_waitcnt lgkmcnt(2)
    buffer_store_dwordx4 v[100:103], v254, s[20:23], s62 offen sc1
    s_add_u32 s62, s62, 2048
    s_waitcnt lgkmcnt(1)
    buffer_store_dwordx4 v[104:107], v254, s[20:23], s62 offen sc1
    s_add_u32 s62, s62, 2048
    s_waitcnt lgkmcnt(0)
    buffer_store_dwordx4 v[108:111], v254, s[20:23], s62 offen sc1
L_yo25:
    s_cmp_lt_u32 s10, 2
    s_cbranch_scc1 L_ws26
    s_waitcnt vmcnt(0)
    s_branch L_ws27
L_ws26:
    s_waitcnt vmcnt(4)
    s_cmp_lg_u32 s10, 0
    s_cbranch_scc1 L_ws27
    v_cmp_gt_u32 vcc, 32, v51
    s_nop 4
    s_cbranch_vccz L_ws27
    s_mov_b32 s60, 12583936
    v_and_b32 v13, 7, v2
    v_lshlrev_b32 v13, 7, v13
    v_add_u32 v13, s60, v13
    s_mov_b32 s61, 0
L_poll29:
    global_load_dword v14, v13, s[6:7] sc1
    s_waitcnt vmcnt(0)
    v_cmp_gt_u32 vcc, 32, v14
    s_add_u32 s61, s61, 1
    s_nop 3
    s_cbranch_vccz L_poll29_done
    s_cmp_lt_u32 s61, 0x40000
    s_cbranch_scc1 L_poll29
L_poll29_done:
L_ws27:
    ds_read_b64_tr_b16 a[0:1], v246 offset:0
    ds_read_b64_tr_b16 a[2:3], v246 offset:512
    ds_read_b64_tr_b16 a[4:5], v247 offset:0
    ds_read_b64_tr_b16 a[6:7], v247 offset:512
    ds_read_b64_tr_b16 a[8:9], v246 offset:2048
    ds_read_b64_tr_b16 a[10:11], v246 offset:2560
    ds_read_b64_tr_b16 a[12:13], v247 offset:2048
    ds_read_b64_tr_b16 a[14:15], v247 offset:2560
    ds_read_b64_tr_b16 a[16:17], v246 offset:4096
    ds_read_b64_tr_b16 a[18:19], v246 offset:4608
    ds_read_b64_tr_b16 a[20:21], v247 offset:4096
    ds_read_b64_tr_b16 a[22:23], v247 offset:4608
    s_waitcnt lgkmcnt(4)
    ds_read_b64_tr_b16 a[24:25], v246 offset:6144
    ds_read_b64_tr_b16 a[26:27], v246 offset:6656
    ds_read_b64_tr_b16 a[28:29], v247 offset:6144
    ds_read_b64_tr_b16 a[30:31], v247 offset:6656
    ds_read_b64_tr_b16 a[32:33], v246 offset:8192
    ds_read_b64_tr_b16 a[34:35], v246 offset:8704
    ds_read_b64_tr_b16 a[36:37], v247 offset:8192
    ds_read_b64_tr_b16 a[38:39], v247 offset:8704
    ds_read_b64_tr_b16 a[40:41], v246 offset:10240
    ds_read_b64_tr_b16 a[42:43], v246 offset:10752
    ds_read_b64_tr_b16 a[44:45], v247 offset:10240
    ds_read_b64_tr_b16 a[46:47], v247 offset:10752
    s_waitcnt lgkmcnt(4)
    ds_read_b64_tr_b16 a[48:49], v246 offset:12288
    ds_read_b64_tr_b16 a[50:51], v246 offset:12800
    ds_read_b64_tr_b16 a[52:53], v247 offset:12288
    ds_read_b64_tr_b16 a[54:55], v247 offset:12800
    ds_read_b64_tr_b16 a[56:57], v246 offset:14336
    ds_read_b64_tr_b16 a[58:59], v246 offset:14848
    ds_read_b64_tr_b16 a[60:61], v247 offset:14336
    ds_read_b64_tr_b16 a[62:63], v247 offset:14848
    ds_read_b64_tr_b16 a[64:65], v246 offset:16384
    ds_read_b64_tr_b16 a[66:67], v246 offset:16896
    ds_read_b64_tr_b16 a[68:69], v247 offset:16384
    ds_read_b64_tr_b16 a[70:71], v247 offset:16896
    s_waitcnt lgkmcnt(4)
    ds_read_b64_tr_b16 a[72:73], v246 offset:18432
    ds_read_b64_tr_b16 a[74:75], v246 offset:18944
    ds_read_b64_tr_b16 a[76:77], v247 offset:18432
    ds_read_b64_tr_b16 a[78:79], v247 offset:18944
    s_waitcnt lgkmcnt(0)
    s_barrier
    s_mul_i32 s59, s10, 28672
    s_add_u32 s59, s59, 25600
    s_lshr_b32 s60, s10, 1
    s_lshl_b32 s60, s60, 6
    v_xor_b32 v246, s60, v241
    v_xor_b32 v247, 64, v246
    v_add_u32 v246, s59, v246
    v_add_u32 v247, s59, v247
    v_lshrrev_b32 v4, 1, v0
    v_lshlrev_b32 v4, 13, v4
    v_and_b32_e64 v5, 1, v0
    v_lshl_add_u32 v4, v5, 4, v4
    s_lshl_b32 s72, s5, 5
    s_add_u32 s73, s72, 0x100000
    s_add_u32 m0, s59, 0
    s_nop 0
    buffer_load_dwordx4 v240, s[36:39], s76 offen lds
    s_add_u32 s76, s76, 57344
    s_add_u32 m0, s59, 1024
    s_nop 0
    buffer_load_dwordx4 v240, s[36:39], s77 offen lds
    s_add_u32 s77, s77, 57344
    s_add_u32 m0, s59, 2048
    s_nop 0
    buffer_load_dwordx4 v240, s[36:39], s76 offen lds
    s_add_u32 s76, s76, 57344
    s_add_u32 m0, s59, 3072
    s_nop 0
    buffer_load_dwordx4 v240, s[36:39], s77 offen lds
    s_add_u32 s77, s77, 57344
    s_add_u32 m0, s59, 4096
    s_nop 0
    buffer_load_dwordx4 v240, s[36:39], s76 offen lds
    s_add_u32 s76, s76, 57344
    s_add_u32 m0, s59, 5120
    s_nop 0
    buffer_load_dwordx4 v240, s[36:39], s77 offen lds
    s_add_u32 s77, s77, 57344
    s_add_u32 m0, s59, 6144
    s_nop 0
    buffer_load_dwordx4 v240, s[36:39], s76 offen lds
    s_add_u32 s76, s76, 57344
    s_add_u32 m0, s59, 7168
    s_nop 0
    buffer_load_dwordx4 v240, s[36:39], s77 offen lds
    s_add_u32 s77, s77, 57344
    s_add_u32 m0, s59, 8192
    s_nop 0
    buffer_load_dwordx4 v240, s[36:39], s76 offen lds
    s_add_u32 s76, s76, 57344
    s_add_u32 m0, s59, 9216
    s_nop 0
    buffer_load_dwordx4 v240, s[36:39], s77 offen lds
    s_add_u32 s77, s77, 57344
    s_add_u32 m0, s59, 10240
    s_nop 0
    buffer_load_dwordx4 v240, s[36:39], s76 offen lds
    s_add_u32 s76, s76, 57344
    s_add_u32 m0, s59, 11264
    s_nop 0
    buffer_load_dwordx4 v240, s[36:39], s77 offen lds
    s_add_u32 s77, s77, 57344
    s_add_u32 m0, s59, 12288
    s_nop 0
    buffer_load_dwordx4 v240, s[36:39], s76 offen lds
    s_add_u32 s76, s76, 57344
    s_add_u32 m0, s59, 13312
    s_nop 0
    buffer_load_dwordx4 v240, s[36:39], s77 offen lds
    s_add_u32 s77, s77, 57344
    s_add_u32 m0, s59, 14336
    s_nop 0
    buffer_load_dwordx4 v240, s[36:39], s76 offen lds
    s_add_u32 s76, s76, 57344
    s_add_u32 m0, s59, 15360
    s_nop 0
    buffer_load_dwordx4 v240, s[36:39], s77 offen lds
    s_add_u32 s77, s77, 57344
    buffer_load_dwordx4 v[40:43], v4, s[20:23], s72 offen sc1
    buffer_load_dwordx4 v[44:47], v4, s[20:23], s73 offen sc1
    s_add_u32 m0, s59, 16384
    s_nop 0
    buffer_load_dwordx4 v240, s[36:39], s76 offen lds
    s_add_u32 s76, s76, 57344
    s_add_u32 m0, s59, 17408
    s_nop 0
    buffer_load_dwordx4 v240, s[36:39], s77 offen lds
    s_add_u32 s77, s77, 57344
    s_add_u32 m0, s59, 18432
    s_nop 0
    buffer_load_dwordx4 v240, s[36:39], s76 offen lds
    s_add_u32 s76, s76, 57344
    s_add_u32 m0, s59, 19456
    s_nop 0
    buffer_load_dwordx4 v240, s[36:39], s77 offen lds
    s_add_u32 s77, s77, 57344
    s_add_u32 m0, s59, 20480
    s_nop 0
    buffer_load_dwordx4 v240, s[36:39], s76 offen lds
    s_add_u32 s76, s76, 57344
    s_add_u32 m0, s59, 21504
    s_nop 0
    buffer_load_dwordx4 v240, s[36:39], s77 offen lds
    s_add_u32 s77, s77, 57344
    s_add_u32 m0, s59, 22528
    s_nop 0
    buffer_load_dwordx4 v240, s[36:39], s76 offen lds
    s_add_u32 s76, s76, 57344
    s_add_u32 m0, s59, 23552
    s_nop 0
    buffer_load_dwordx4 v240, s[36:39], s77 offen lds
    s_add_u32 s77, s77, 57344
    s_add_u32 m0, s59, 24576
    s_nop 0
    buffer_load_dwordx4 v240, s[36:39], s76 offen lds
    s_add_u32 s76, s76, 57344
    s_add_u32 m0, s59, 25600
    s_nop 0
    buffer_load_dwordx4 v240, s[36:39], s77 offen lds
    s_add_u32 s77, s77, 57344
    s_add_u32 m0, s59, 26624
    s_nop 0
    buffer_load_dwordx4 v240, s[36:39], s76 offen lds
    s_add_u32 s76, s76, 57344
    s_add_u32 m0, s59, 27648
    s_nop 0
    buffer_load_dwordx4 v240, s[36:39], s77 offen lds
    s_add_u32 s77, s77, 57344
    s_mov_b32 s61, 0
    s_waitcnt vmcnt(12)
    s_branch L_ys30_c
L_ys30:
    buffer_load_dwordx4 v[40:43], v4, s[20:23], s72 offen sc1
    buffer_load_dwordx4 v[44:47], v4, s[20:23], s73 offen sc1
    s_add_u32 s61, s61, 1
    s_waitcnt vmcnt(0)
L_ys30_c:
    v_max3_u32 v12, v40, v41, v42
    v_max3_u32 v12, v12, v43, v44
    v_max3_u32 v12, v12, v45, v46
    v_max_u32 v12, v12, v47
    v_cmp_eq_u32 vcc, -1, v12
    s_nop 4
    s_cbranch_vccz L_ys30_ok
    s_cmp_lt_u32 s61, 131072
    s_cbranch_scc1 L_ys30
L_ys30_ok:
    s_waitcnt vmcnt(0)
    s_mul_i32 s60, s10, 448
    s_and_b32 s61, s56, 3
    s_mul_i32 s61, s61, 56
    s_add_u32 s60, s60, s61
    v_min_u32 v13, 55, v2
    v_add_u32 v13, s60, v13
    v_lshlrev_b32 v13, 12, v13
    s_lshl_b32 s60, s57, 7
    buffer_load_dword a199, v13, s[40:43], s60 offen
    v_subrev_u32 v252, 67744, v252
    v_subrev_u32 v253, 67744, v253
    v_mov_b32_e64 v48, v253
    v_add_u32 v49, 1152, v253
    ds_write2st64_b32 v48, v40, v41 offset0:0 offset1:9
    ds_write2st64_b32 v48, v42, v43 offset0:18 offset1:27
    ds_write2st64_b32 v49, v44, v45 offset0:0 offset1:9
    ds_write2st64_b32 v49, v46, v47 offset0:18 offset1:27
    s_waitcnt lgkmcnt(0)
    s_barrier
    ds_read_b32 v40, v252 offset:0
    ds_read_b32 v41, v252 offset:32
    ds_read_b32 v42, v252 offset:64
    ds_read_b32 v43, v252 offset:96
    ds_read_b32 v44, v252 offset:128
    ds_read_b32 v45, v252 offset:160
    ds_read_b32 v46, v252 offset:192
    ds_read_b32 v47, v252 offset:224
    s_mov_b32 s90, 989855744
    s_mov_b32 s91, 925353388
    s_mov_b32 s92, 0x05040100
    s_mov_b32 s93, 0x07060302
    v_lshlrev_b32 v16, 16, v224
    v_lshlrev_b32 v17, 16, v228
    ds_read_b64_tr_b16 a[80:81], v246 offset:0
    ds_read_b64_tr_b16 a[82:83], v246 offset:512
    ds_read_b64_tr_b16 a[84:85], v247 offset:0
    ds_read_b64_tr_b16 a[86:87], v247 offset:512
    v_and_b32 v18, 0xffff0000, v224
    v_and_b32 v19, 0xffff0000, v228
    v_lshlrev_b32 v20, 16, v225
    v_lshlrev_b32 v21, 16, v229
    v_and_b32 v22, 0xffff0000, v225
    v_and_b32 v23, 0xffff0000, v229
    v_lshlrev_b32 v24, 16, v226
    v_lshlrev_b32 v25, 16, v230
    ds_read_b64_tr_b16 a[88:89], v246 offset:2048
    ds_read_b64_tr_b16 a[90:91], v246 offset:2560
    ds_read_b64_tr_b16 a[92:93], v247 offset:2048
    ds_read_b64_tr_b16 a[94:95], v247 offset:2560
    v_and_b32 v26, 0xffff0000, v226
    v_and_b32 v27, 0xffff0000, v230
    v_lshlrev_b32 v28, 16, v227
    v_lshlrev_b32 v29, 16, v231
    v_and_b32 v30, 0xffff0000, v227
    v_and_b32 v31, 0xffff0000, v231
    v_lshlrev_b32 v3, 4, v2
    s_lshl_b32 s64, s5, 13
    ds_read_b64_tr_b16 a[96:97], v246 offset:4096
    ds_read_b64_tr_b16 a[98:99], v246 offset:4608
    ds_read_b64_tr_b16 a[100:101], v247 offset:4096
    ds_read_b64_tr_b16 a[102:103], v247 offset:4608
    s_lshl_b32 s65, s10, 11
    s_add_u32 s64, s64, s65
    s_waitcnt lgkmcnt(0)
    v_lshlrev_b32 v48, 16, v40
    v_and_b32 v49, 0xffff0000, v40
    v_lshlrev_b32_e64 v50, 16, v41
    v_and_b32 v51, 0xffff0000, v41
    v_lshlrev_b32_e64 v52, 16, v42
    ds_read_b64_tr_b16 a[104:105], v246 offset:6144
    ds_read_b64_tr_b16 a[106:107], v246 offset:6656
    ds_read_b64_tr_b16 a[108:109], v247 offset:6144
    ds_read_b64_tr_b16 a[110:111], v247 offset:6656
    v_and_b32 v53, 0xffff0000, v42
    v_lshlrev_b32_e64 v54, 16, v43
    v_and_b32 v55, 0xffff0000, v43
    v_lshlrev_b32_e64 v56, 16, v44
    v_and_b32 v57, 0xffff0000, v44
    v_lshlrev_b32_e64 v58, 16, v45
    v_and_b32 v59, 0xffff0000, v45
    v_lshlrev_b32_e64 v60, 16, v46
    ds_read_b64_tr_b16 a[112:113], v246 offset:8192
    ds_read_b64_tr_b16 a[114:115], v246 offset:8704
    ds_read_b64_tr_b16 a[116:117], v247 offset:8192
    ds_read_b64_tr_b16 a[118:119], v247 offset:8704
    v_and_b32 v61, 0xffff0000, v46
    v_lshlrev_b32_e64 v62, 16, v47
    v_and_b32 v63, 0xffff0000, v47
    v_pk_add_f32 v[16:17], v[16:17], v[48:49]
    v_pk_add_f32 v[18:19], v[18:19], v[50:51]
    v_pk_add_f32 v[20:21], v[20:21], v[52:53]
    v_pk_add_f32 v[22:23], v[22:23], v[54:55]
    v_pk_add_f32 v[24:25], v[24:25], v[56:57]
    ds_read_b64_tr_b16 a[120:121], v246 offset:10240
    ds_read_b64_tr_b16 a[122:123], v246 offset:10752
    ds_read_b64_tr_b16 a[124:125], v247 offset:10240
    ds_read_b64_tr_b16 a[126:127], v247 offset:10752
    v_pk_add_f32 v[26:27], v[26:27], v[58:59]
    v_pk_add_f32 v[28:29], v[28:29], v[60:61]
    v_pk_add_f32 v[30:31], v[30:31], v[62:63]
    v_cvt_pk_bf16_f32 v40, v16, v17
    v_cvt_pk_bf16_f32 v41, v18, v19
    v_cvt_pk_bf16_f32 v42, v20, v21
    v_cvt_pk_bf16_f32 v43, v22, v23
    v_cvt_pk_bf16_f32 v44, v24, v25
    ds_read_b64_tr_b16 a[128:129], v246 offset:12288
    ds_read_b64_tr_b16 a[130:131], v246 offset:12800
    ds_read_b64_tr_b16 a[132:133], v247 offset:12288
    ds_read_b64_tr_b16 a[134:135], v247 offset:12800
    v_cvt_pk_bf16_f32 v45, v26, v27
    v_cvt_pk_bf16_f32 v46, v28, v29
    v_cvt_pk_bf16_f32 v47, v30, v31
    v_lshlrev_b32_e64 v16, 16, v40
    v_and_b32 v17, 0xffff0000, v40
    v_lshlrev_b32_e64 v18, 16, v41
    v_and_b32 v19, 0xffff0000, v41
    v_lshlrev_b32_e64 v20, 16, v42
    ds_read_b64_tr_b16 a[136:137], v246 offset:14336
    ds_read_b64_tr_b16 a[138:139], v246 offset:14848
    ds_read_b64_tr_b16 a[140:141], v247 offset:14336
    ds_read_b64_tr_b16 a[142:143], v247 offset:14848
    v_and_b32 v21, 0xffff0000, v42
    v_lshlrev_b32_e64 v22, 16, v43
    v_and_b32 v23, 0xffff0000, v43
    v_lshlrev_b32_e64 v24, 16, v44
    v_and_b32 v25, 0xffff0000, v44
    v_lshlrev_b32_e64 v26, 16, v45
    v_and_b32 v27, 0xffff0000, v45
    v_lshlrev_b32 v28, 16, v46
    s_waitcnt lgkmcnt(0)
    s_add_u32 m0, s59, 0
    s_nop 0
    buffer_load_dwordx4 v240, s[36:39], s76 offen lds
    s_add_u32 s76, s76, 57344
    v_and_b32 v29, 0xffff0000, v46
    v_lshlrev_b32_e64 v30, 16, v47
    v_and_b32 v31, 0xffff0000, v47
    v_perm_b32 v4, v41, v40, s92
    v_perm_b32 v8, v41, v40, s93
    v_perm_b32 v5, v43, v42, s92
    v_perm_b32 v9, v43, v42, s93
    v_perm_b32 v6, v45, v44, s92
    s_add_u32 m0, s59, 1024
    s_nop 0
    buffer_load_dwordx4 v240, s[36:39], s77 offen lds
    s_nop 0
    s_add_u32 s77, s77, 57344
    v_perm_b32 v10, v45, v44, s93
    v_perm_b32 v7, v47, v46, s92
    v_perm_b32 v11, v47, v46, s93
    buffer_store_dwordx4 v[4:7], v3, s[24:27], s64 offen sc1
    buffer_store_dwordx4 v[8:11], v3, s[24:27], s64 offen offset:1024 sc1
    v_pk_add_f32 v[32:33], v[16:17], v[18:19]
    v_pk_mul_f32 v[34:35], v[16:17], v[16:17]
    v_pk_add_f32 v[36:37], v[20:21], v[22:23]
    ds_read_b64_tr_b16 a[144:145], v246 offset:16384
    ds_read_b64_tr_b16 a[146:147], v246 offset:16896
    ds_read_b64_tr_b16 a[148:149], v247 offset:16384
    ds_read_b64_tr_b16 a[150:151], v247 offset:16896
    v_pk_mul_f32 v[38:39], v[18:19], v[18:19]
    v_pk_fma_f32 v[34:35], v[20:21], v[20:21], v[34:35]
    v_pk_fma_f32 v[38:39], v[22:23], v[22:23], v[38:39]
    v_pk_fma_f32 v[34:35], v[24:25], v[24:25], v[34:35]
    v_pk_add_f32 v[32:33], v[32:33], v[24:25]
    v_pk_fma_f32 v[38:39], v[26:27], v[26:27], v[38:39]
    v_pk_add_f32 v[36:37], v[36:37], v[26:27]
    v_pk_fma_f32 v[34:35], v[28:29], v[28:29], v[34:35]
    s_add_u32 m0, s59, 2048
    s_nop 0
    buffer_load_dwordx4 v240, s[36:39], s76 offen lds
    s_nop 0
    s_add_u32 s76, s76, 57344
    v_pk_add_f32 v[32:33], v[32:33], v[28:29]
    v_pk_fma_f32 v[38:39], v[30:31], v[30:31], v[38:39]
    v_pk_add_f32 v[36:37], v[36:37], v[30:31]
    v_pk_add_f32 v[32:33], v[32:33], v[36:37]
    v_pk_add_f32 v[34:35], v[34:35], v[38:39]
    s_nop 0
    v_permlane32_swap_b32 v32, v33
    v_permlane32_swap_b32 v34, v35
    v_add_f32 v32, v32, v33
    s_add_u32 m0, s59, 3072
    s_nop 0
    buffer_load_dwordx4 v240, s[36:39], s77 offen lds
    s_add_u32 s77, s77, 57344
    v_add_f32 v34, v34, v35
    s_nop 1
    v_permlane16_swap_b32 v32, v34
    v_add_f32 v32, v32, v34
    s_nop 1
    v_add_f32_dpp v32, v32, v32 row_ror:8 row_mask:0xf bank_mask:0xf
    s_nop 1
    v_add_f32_dpp v32, v32, v32 row_ror:4 row_mask:0xf bank_mask:0xf
    s_nop 1
    v_add_f32_dpp v32, v32, v32 row_ror:2 row_mask:0xf bank_mask:0xf
    s_nop 1
    v_add_f32_dpp v32, v32, v32 row_ror:1 row_mask:0xf bank_mask:0xf
    v_mov_b32 v33, v32
    ds_read_b64_tr_b16 a[152:153], v246 offset:18432
    ds_read_b64_tr_b16 a[154:155], v246 offset:18944
    ds_read_b64_tr_b16 a[156:157], v247 offset:18432
    ds_read_b64_tr_b16 a[158:159], v247 offset:18944
    v_permlane16_swap_b32 v32, v33
    v_mul_f32 v32, s90, v32
    v_mul_f32_e64 v33, s90, v33
    v_fma_f32 v33, -v32, v32, v33
    v_max_f32_e64 v33, 0, v33
    v_cvt_pk_bf16_f32 v36, v32, v33
    v_lshlrev_b32_e64 v32, 16, v36
    v_and_b32 v33, 0xffff0000, v36
    s_add_u32 m0, s59, 4096
    s_nop 0
    buffer_load_dwordx4 v240, s[36:39], s76 offen lds
    s_add_u32 s76, s76, 57344
    v_add_f32 v33, s91, v33
    v_cvt_pk_bf16_f32 v33, v33, v33
    v_lshlrev_b32 v33, 16, v33
    v_sqrt_f32 v33, v33
    s_nop 0
    v_cvt_pk_bf16_f32 v33, v33, v33
    v_lshlrev_b32 v33, 16, v33
    v_rcp_f32_e64 v33, v33
    v_readlane_b32 s84, v32, 0
    s_add_u32 m0, s59, 5120
    s_nop 0
    buffer_load_dwordx4 v240, s[36:39], s77 offen lds
    s_nop 0
    s_add_u32 s77, s77, 57344
    v_readlane_b32 s85, v32, 32
    v_readlane_b32 s86, v33, 0
    v_readlane_b32 s87, v33, 32
    v_pk_add_f32 v[16:17], v[16:17], s[84:85] neg_lo:[0,1] neg_hi:[0,1]
    v_pk_add_f32 v[18:19], v[18:19], s[84:85] neg_lo:[0,1] neg_hi:[0,1]
    v_pk_add_f32 v[20:21], v[20:21], s[84:85] neg_lo:[0,1] neg_hi:[0,1]
    v_pk_add_f32 v[22:23], v[22:23], s[84:85] neg_lo:[0,1] neg_hi:[0,1]
    v_pk_add_f32 v[24:25], v[24:25], s[84:85] neg_lo:[0,1] neg_hi:[0,1]
    ds_read_b64_tr_b16 a[160:161], v246 offset:20480
    ds_read_b64_tr_b16 a[162:163], v246 offset:20992
    ds_read_b64_tr_b16 a[164:165], v247 offset:20480
    ds_read_b64_tr_b16 a[166:167], v247 offset:20992
    v_pk_add_f32 v[26:27], v[26:27], s[84:85] neg_lo:[0,1] neg_hi:[0,1]
    v_pk_add_f32 v[28:29], v[28:29], s[84:85] neg_lo:[0,1] neg_hi:[0,1]
    v_pk_add_f32 v[30:31], v[30:31], s[84:85] neg_lo:[0,1] neg_hi:[0,1]
    v_cvt_pk_bf16_f32 v40, v16, v17
    v_cvt_pk_bf16_f32 v41, v18, v19
    v_cvt_pk_bf16_f32 v42, v20, v21
    v_cvt_pk_bf16_f32 v43, v22, v23
    v_cvt_pk_bf16_f32 v44, v24, v25
    s_add_u32 m0, s59, 6144
    s_nop 0
    buffer_load_dwordx4 v240, s[36:39], s76 offen lds
    s_add_u32 s76, s76, 57344
    v_cvt_pk_bf16_f32 v45, v26, v27
    v_cvt_pk_bf16_f32 v46, v28, v29
    v_cvt_pk_bf16_f32 v47, v30, v31
    v_lshlrev_b32 v16, 16, v40
    v_and_b32 v17, 0xffff0000, v40
    v_lshlrev_b32_e64 v18, 16, v41
    v_and_b32 v19, 0xffff0000, v41
    v_lshlrev_b32_e64 v20, 16, v42
    s_add_u32 m0, s59, 7168
    s_nop 0
    buffer_load_dwordx4 v240, s[36:39], s77 offen lds
    s_add_u32 s77, s77, 57344
    v_and_b32 v21, 0xffff0000, v42
    v_lshlrev_b32 v22, 16, v43
    v_and_b32 v23, 0xffff0000, v43
    v_lshlrev_b32_e64 v24, 16, v44
    v_and_b32 v25, 0xffff0000, v44
    v_lshlrev_b32_e64 v26, 16, v45
    v_and_b32 v27, 0xffff0000, v45
    v_lshlrev_b32_e64 v28, 16, v46
    ds_read_b64_tr_b16 a[168:169], v246 offset:22528
    ds_read_b64_tr_b16 a[170:171], v246 offset:23040
    ds_read_b64_tr_b16 a[172:173], v247 offset:22528
    ds_read_b64_tr_b16 a[174:175], v247 offset:23040
    v_and_b32 v29, 0xffff0000, v46
    v_lshlrev_b32_e64 v30, 16, v47
    v_and_b32 v31, 0xffff0000, v47
    v_pk_mul_f32 v[16:17], v[16:17], s[86:87]
    v_pk_mul_f32 v[18:19], v[18:19], s[86:87]
    v_pk_mul_f32 v[20:21], v[20:21], s[86:87]
    v_pk_mul_f32 v[22:23], v[22:23], s[86:87]
    v_pk_mul_f32 v[24:25], v[24:25], s[86:87]
    s_add_u32 m0, s59, 8192
    s_nop 0
    buffer_load_dwordx4 v240, s[36:39], s76 offen lds
    s_nop 0
    s_add_u32 s76, s76, 57344
    v_pk_mul_f32 v[26:27], v[26:27], s[86:87]
    v_pk_mul_f32 v[28:29], v[28:29], s[86:87]
    v_pk_mul_f32 v[30:31], v[30:31], s[86:87]
    v_cvt_pk_bf16_f32 v40, v16, v17
    v_cvt_pk_bf16_f32 v41, v18, v19
    v_cvt_pk_bf16_f32 v42, v20, v21
    v_cvt_pk_bf16_f32 v43, v22, v23
    v_cvt_pk_bf16_f32 v44, v24, v25
    s_add_u32 m0, s59, 9216
    s_nop 0
    buffer_load_dwordx4 v240, s[36:39], s77 offen lds
    s_add_u32 s77, s77, 57344
    v_cvt_pk_bf16_f32 v45, v26, v27
    v_cvt_pk_bf16_f32 v46, v28, v29
    v_cvt_pk_bf16_f32 v47, v30, v31
    v_lshlrev_b32 v16, 16, v40
    v_and_b32 v17, 0xffff0000, v40
    v_lshlrev_b32_e64 v18, 16, v41
    v_and_b32 v19, 0xffff0000, v41
    v_lshlrev_b32_e64 v20, 16, v42
    ds_read_b64_tr_b16 a[176:177], v246 offset:24576
    ds_read_b64_tr_b16 a[178:179], v246 offset:25088
    ds_read_b64_tr_b16 a[180:181], v247 offset:24576
    ds_read_b64_tr_b16 a[182:183], v247 offset:25088
    v_and_b32 v21, 0xffff0000, v42
    v_lshlrev_b32_e64 v22, 16, v43
    v_and_b32 v23, 0xffff0000, v43
    v_lshlrev_b32_e64 v24, 16, v44
    v_and_b32 v25, 0xffff0000, v44
    v_lshlrev_b32_e64 v26, 16, v45
    v_and_b32 v27, 0xffff0000, v45
    v_lshlrev_b32_e64 v28, 16, v46
    s_add_u32 m0, s59, 10240
    s_nop 0
    buffer_load_dwordx4 v240, s[36:39], s76 offen lds
    s_add_u32 s76, s76, 57344
    v_and_b32 v29, 0xffff0000, v46
    v_lshlrev_b32 v30, 16, v47
    v_and_b32 v31, 0xffff0000, v47
    v_pk_add_f32 v[32:33], v[16:17], v[18:19]
    v_pk_mul_f32 v[34:35], v[16:17], v[16:17]
    v_pk_add_f32 v[36:37], v[20:21], v[22:23]
    v_pk_mul_f32 v[38:39], v[18:19], v[18:19]
    v_pk_fma_f32 v[34:35], v[20:21], v[20:21], v[34:35]
    s_add_u32 m0, s59, 11264
    s_nop 0
    buffer_load_dwordx4 v240, s[36:39], s77 offen lds
    s_nop 0
    s_add_u32 s77, s77, 57344
    v_pk_fma_f32 v[38:39], v[22:23], v[22:23], v[38:39]
    v_pk_fma_f32 v[34:35], v[24:25], v[24:25], v[34:35]
    v_pk_add_f32 v[32:33], v[32:33], v[24:25]
    v_pk_fma_f32 v[38:39], v[26:27], v[26:27], v[38:39]
    v_pk_add_f32 v[36:37], v[36:37], v[26:27]
    v_pk_fma_f32 v[34:35], v[28:29], v[28:29], v[34:35]
    v_pk_add_f32 v[32:33], v[32:33], v[28:29]
    v_pk_fma_f32 v[38:39], v[30:31], v[30:31], v[38:39]
    ds_read_b64_tr_b16 a[184:185], v246 offset:26624
    ds_read_b64_tr_b16 a[186:187], v246 offset:27136
    ds_read_b64_tr_b16 a[188:189], v247 offset:26624
    ds_read_b64_tr_b16 a[190:191], v247 offset:27136
    v_pk_add_f32 v[36:37], v[36:37], v[30:31]
    v_pk_add_f32 v[32:33], v[32:33], v[36:37]
    v_pk_add_f32 v[34:35], v[34:35], v[38:39]
    s_nop 0
    v_permlane32_swap_b32 v32, v33
    v_permlane32_swap_b32 v34, v35
    v_add_f32 v32, v32, v33
    v_add_f32 v34, v34, v35
    s_nop 1
    v_permlane16_swap_b32 v32, v34
    s_add_u32 m0, s59, 12288
    s_nop 0
    buffer_load_dwordx4 v240, s[36:39], s76 offen lds
    s_add_u32 s76, s76, 57344
    v_add_f32 v32, v32, v34
    s_nop 1
    v_add_f32_dpp v32, v32, v32 row_ror:8 row_mask:0xf bank_mask:0xf
    s_nop 1
    v_add_f32_dpp v32, v32, v32 row_ror:4 row_mask:0xf bank_mask:0xf
    s_nop 1
    v_add_f32_dpp v32, v32, v32 row_ror:2 row_mask:0xf bank_mask:0xf
    s_nop 1
    v_add_f32_dpp v32, v32, v32 row_ror:1 row_mask:0xf bank_mask:0xf
    v_mov_b32 v33, v32
    s_nop 1
    v_permlane16_swap_b32 v32, v33
    v_mul_f32_e64 v32, s90, v32
    s_add_u32 m0, s59, 13312
    s_nop 0
    buffer_load_dwordx4 v240, s[36:39], s77 offen lds
    s_add_u32 s77, s77, 57344
    v_mul_f32 v33, s90, v33
    v_fma_f32 v33, -v32, v32, v33
    v_max_f32_e64 v33, 0, v33
    v_cvt_pk_bf16_f32 v36, v32, v33
    v_lshlrev_b32_e64 v32, 16, v36
    v_and_b32 v33, 0xffff0000, v36
    v_add_f32_e64 v33, s91, v33
    v_cvt_pk_bf16_f32 v33, v33, v33
    s_add_u32 m0, s59, 14336
    s_nop 0
    buffer_load_dwordx4 v240, s[36:39], s76 offen lds
    s_add_u32 s76, s76, 57344
    v_lshlrev_b32 v33, 16, v33
    v_sqrt_f32 v33, v33
    s_nop 0
    v_cvt_pk_bf16_f32 v33, v33, v33
    v_lshlrev_b32 v33, 16, v33
    v_rcp_f32 v33, v33
    v_readlane_b32 s84, v32, 0
    v_readlane_b32 s85, v32, 32
    v_readlane_b32 s86, v33, 0
    s_add_u32 m0, s59, 15360
    s_nop 0
    buffer_load_dwordx4 v240, s[36:39], s77 offen lds
    s_nop 0
    s_add_u32 s77, s77, 57344
    v_readlane_b32 s87, v33, 32
    v_pk_add_f32 v[16:17], v[16:17], s[84:85] neg_lo:[0,1] neg_hi:[0,1]
    v_pk_add_f32 v[18:19], v[18:19], s[84:85] neg_lo:[0,1] neg_hi:[0,1]
    v_pk_add_f32 v[20:21], v[20:21], s[84:85] neg_lo:[0,1] neg_hi:[0,1]
    v_pk_add_f32 v[22:23], v[22:23], s[84:85] neg_lo:[0,1] neg_hi:[0,1]
    v_pk_add_f32 v[24:25], v[24:25], s[84:85] neg_lo:[0,1] neg_hi:[0,1]
    v_pk_add_f32 v[26:27], v[26:27], s[84:85] neg_lo:[0,1] neg_hi:[0,1]
    v_pk_add_f32 v[28:29], v[28:29], s[84:85] neg_lo:[0,1] neg_hi:[0,1]
    v_pk_add_f32 v[30:31], v[30:31], s[84:85] neg_lo:[0,1] neg_hi:[0,1]
    v_cvt_pk_bf16_f32 v40, v16, v17
    v_cvt_pk_bf16_f32 v41, v18, v19
    v_cvt_pk_bf16_f32 v42, v20, v21
    v_cvt_pk_bf16_f32 v43, v22, v23
    v_cvt_pk_bf16_f32 v44, v24, v25
    v_cvt_pk_bf16_f32 v45, v26, v27
    v_cvt_pk_bf16_f32 v46, v28, v29
    v_cvt_pk_bf16_f32 v47, v30, v31
    v_lshlrev_b32_e64 v16, 16, v40
    v_and_b32 v17, 0xffff0000, v40
    v_lshlrev_b32_e64 v18, 16, v41
    v_and_b32 v19, 0xffff0000, v41
    v_lshlrev_b32_e64 v20, 16, v42
    v_and_b32 v21, 0xffff0000, v42
    v_lshlrev_b32_e64 v22, 16, v43
    v_and_b32 v23, 0xffff0000, v43
    v_lshlrev_b32_e64 v24, 16, v44
    v_and_b32 v25, 0xffff0000, v44
    v_lshlrev_b32_e64 v26, 16, v45
    v_and_b32 v27, 0xffff0000, v45
    v_lshlrev_b32_e64 v28, 16, v46
    v_and_b32 v29, 0xffff0000, v46
    v_lshlrev_b32_e64 v30, 16, v47
    v_and_b32 v31, 0xffff0000, v47
    v_pk_mul_f32 v[16:17], v[16:17], s[86:87]
    v_pk_mul_f32 v[18:19], v[18:19], s[86:87]
    v_pk_mul_f32 v[20:21], v[20:21], s[86:87]
    v_pk_mul_f32 v[22:23], v[22:23], s[86:87]
    v_pk_mul_f32 v[24:25], v[24:25], s[86:87]
    v_pk_mul_f32 v[26:27], v[26:27], s[86:87]
    v_pk_mul_f32 v[28:29], v[28:29], s[86:87]
    v_pk_mul_f32 v[30:31], v[30:31], s[86:87]
    v_cvt_pk_bf16_f32 v40, v16, v17
    v_cvt_pk_bf16_f32 v41, v18, v19
    v_cvt_pk_bf16_f32 v42, v20, v21
    v_cvt_pk_bf16_f32 v43, v22, v23
    v_cvt_pk_bf16_f32 v44, v24, v25
    v_cvt_pk_bf16_f32 v45, v26, v27
    v_cvt_pk_bf16_f32 v46, v28, v29
    v_cvt_pk_bf16_f32 v47, v30, v31
    s_waitcnt vmcnt(0)
    s_barrier
    ds_write_b32 v252, v40 offset:0
    ds_write_b32 v252, v41 offset:32
    ds_write_b32 v252, v42 offset:64
    ds_write_b32 v252, v43 offset:96
    ds_write_b32 v252, v44 offset:128
    ds_write_b32 v252, v45 offset:160
    ds_write_b32 v252, v46 offset:192
    ds_write_b32 v252, v47 offset:224
    s_waitcnt lgkmcnt(0)
    s_barrier
    s_lshl_b32 s60, s5, 13
    s_nop 0
    v_add_u32 v56, 1152, v253
    ds_read2st64_b32 v[48:49], v253 offset0:0 offset1:9
    ds_read2st64_b32 v[50:51], v253 offset0:18 offset1:27
    ds_read2st64_b32 v[52:53], v56 offset0:0 offset1:9
    ds_read2st64_b32 v[54:55], v56 offset0:18 offset1:27
    s_add_u32 s61, s60, 4096
    s_waitcnt lgkmcnt(2)
    buffer_store_dwordx4 v[48:51], v254, s[28:31], s60 offen sc1
    s_waitcnt lgkmcnt(0)
    buffer_store_dwordx4 v[52:55], v254, s[28:31], s61 offen sc1
    ds_read_b64_tr_b16 a[192:193], v246 offset:0
    ds_read_b64_tr_b16 a[194:195], v246 offset:512
    ds_read_b64_tr_b16 a[196:197], v247 offset:0
    ds_read_b64_tr_b16 a[198:199], v247 offset:512
    ds_read_b64_tr_b16 a[200:201], v246 offset:2048
    ds_read_b64_tr_b16 a[202:203], v246 offset:2560
    ds_read_b64_tr_b16 a[204:205], v247 offset:2048
    ds_read_b64_tr_b16 a[206:207], v247 offset:2560
    ds_read_b64_tr_b16 a[208:209], v246 offset:4096
    ds_read_b64_tr_b16 a[210:211], v246 offset:4608
    ds_read_b64_tr_b16 a[212:213], v247 offset:4096
    ds_read_b64_tr_b16 a[214:215], v247 offset:4608
    s_waitcnt lgkmcnt(4)
    ds_read_b64_tr_b16 a[216:217], v246 offset:6144
    ds_read_b64_tr_b16 a[218:219], v246 offset:6656
    ds_read_b64_tr_b16 a[220:221], v247 offset:6144
    ds_read_b64_tr_b16 a[222:223], v247 offset:6656
    ds_read_b64_tr_b16 a[224:225], v246 offset:8192
    ds_read_b64_tr_b16 a[226:227], v246 offset:8704
    ds_read_b64_tr_b16 a[228:229], v247 offset:8192
    ds_read_b64_tr_b16 a[230:231], v247 offset:8704
    ds_read_b64_tr_b16 a[232:233], v246 offset:10240
    ds_read_b64_tr_b16 a[234:235], v246 offset:10752
    ds_read_b64_tr_b16 a[236:237], v247 offset:10240
    ds_read_b64_tr_b16 a[238:239], v247 offset:10752
    s_waitcnt lgkmcnt(4)
    ds_read_b64_tr_b16 a[240:241], v246 offset:12288
    ds_read_b64_tr_b16 a[242:243], v246 offset:12800
    ds_read_b64_tr_b16 a[244:245], v247 offset:12288
    ds_read_b64_tr_b16 a[246:247], v247 offset:12800
    ds_read_b64_tr_b16 a[248:249], v246 offset:14336
    ds_read_b64_tr_b16 a[250:251], v246 offset:14848
    ds_read_b64_tr_b16 a[252:253], v247 offset:14336
    ds_read_b64_tr_b16 a[254:255], v247 offset:14848
    s_mul_i32 s71, s10, 524288
    s_lshl_b32 s60, s54, 10
    s_add_u32 s71, s71, s60
    v_lshlrev_b32_e64 v15, 13, v2
    v_add_u32 v15, 1020, v15
    v_lshrrev_b32 v6, 5, v2
    v_and_b32 v7, 31, v2
    v_lshlrev_b32_e64 v10, 13, v6
    v_lshl_add_u32 v10, v7, 4, v10
    s_and_b32 s60, s10, 1
    s_lshl_b32 s60, s60, 9
    v_xor_b32_e64 v8, s60, v10
    v_xor_b32 v9, 512, v8
    v_lshrrev_b32_e64 v240, 3, v2
    v_mul_u32_u24 v240, 4096, v240
    v_and_b32 v243, 7, v2
    v_lshrrev_b32 v244, 2, v2
    v_and_b32 v244, 4, v244
    v_xor_b32 v243, v243, v244
    v_lshl_add_u32 v240, v243, 4, v240
    v_bfe_u32 v243, v2, 2, 2
    v_and_b32_e64 v244, 3, v2
    v_bfe_u32 v241, v2, 4, 1
    v_lshlrev_b32 v241, 1, v241
    v_lshrrev_b32 v245, 1, v244
    v_add_u32 v241, v241, v245
    v_lshrrev_b32 v245, 1, v243
    v_lshlrev_b32 v245, 2, v245
    v_xor_b32 v241, v241, v245
    v_lshlrev_b32 v241, 4, v241
    v_and_b32 v245, 1, v244
    v_lshl_add_u32 v241, v245, 3, v241
    v_lshrrev_b32 v245, 5, v2
    v_lshlrev_b32 v245, 2, v245
    v_add_u32_e64 v245, v245, v243
    v_lshl_add_u32 v241, v245, 7, v241
    v_xor_b32 v242, 64, v241
    s_waitcnt lgkmcnt(0)
    s_barrier
    s_mul_i32 s59, s10, 28672
    s_add_u32 s59, s59, 49152
    s_lshr_b32 s60, s10, 1
    s_lshl_b32 s60, s60, 6
    v_xor_b32 v246, s60, v241
    v_xor_b32 v247, 64, v246
    v_add_u32 v246, s59, v246
    v_add_u32_e64 v247, s59, v247
    s_mul_i32 s76, s10, 1835008
    s_lshl_b32 s60, s57, 7
    s_add_u32 s76, s76, s60
    s_add_u32 s77, s76, 32768
    s_add_u32 m0, s59, 0
    s_nop 0
    buffer_load_dwordx4 v240, s[40:43], s76 offen lds
    s_add_u32 s76, s76, 65536
    s_add_u32 m0, s59, 1024
    s_nop 0
    buffer_load_dwordx4 v240, s[40:43], s77 offen lds
    s_add_u32 s77, s77, 65536
    s_add_u32 m0, s59, 2048
    s_nop 0
    buffer_load_dwordx4 v240, s[40:43], s76 offen lds
    s_add_u32 s76, s76, 65536
    s_add_u32 m0, s59, 3072
    s_nop 0
    buffer_load_dwordx4 v240, s[40:43], s77 offen lds
    s_add_u32 s77, s77, 65536
    s_add_u32 m0, s59, 4096
    s_nop 0
    buffer_load_dwordx4 v240, s[40:43], s76 offen lds
    s_add_u32 s76, s76, 65536
    s_add_u32 m0, s59, 5120
    s_nop 0
    buffer_load_dwordx4 v240, s[40:43], s77 offen lds
    s_add_u32 s77, s77, 65536
    s_add_u32 m0, s59, 6144
    s_nop 0
    buffer_load_dwordx4 v240, s[40:43], s76 offen lds
    s_add_u32 s76, s76, 65536
    s_add_u32 m0, s59, 7168
    s_nop 0
    buffer_load_dwordx4 v240, s[40:43], s77 offen lds
    s_add_u32 s77, s77, 65536
    s_add_u32 m0, s59, 8192
    s_nop 0
    buffer_load_dwordx4 v240, s[40:43], s76 offen lds
    s_add_u32 s76, s76, 65536
    s_add_u32 m0, s59, 9216
    s_nop 0
    buffer_load_dwordx4 v240, s[40:43], s77 offen lds
    s_add_u32 s77, s77, 65536
    s_add_u32 m0, s59, 10240
    s_nop 0
    buffer_load_dwordx4 v240, s[40:43], s76 offen lds
    s_add_u32 s76, s76, 65536
    s_add_u32 m0, s59, 11264
    s_nop 0
    buffer_load_dwordx4 v240, s[40:43], s77 offen lds
    s_add_u32 s77, s77, 65536
    s_add_u32 m0, s59, 12288
    s_nop 0
    buffer_load_dwordx4 v240, s[40:43], s76 offen lds
    s_add_u32 s76, s76, 65536
    s_add_u32 m0, s59, 13312
    s_nop 0
    buffer_load_dwordx4 v240, s[40:43], s77 offen lds
    s_add_u32 s77, s77, 65536
    s_add_u32 m0, s59, 14336
    s_nop 0
    buffer_load_dwordx4 v240, s[40:43], s76 offen lds
    s_add_u32 s76, s76, 65536
    s_add_u32 m0, s59, 15360
    s_nop 0
    buffer_load_dwordx4 v240, s[40:43], s77 offen lds
    s_add_u32 s77, s77, 65536
    s_add_u32 m0, s59, 16384
    s_nop 0
    buffer_load_dwordx4 v240, s[40:43], s76 offen lds
    s_add_u32 s76, s76, 65536
    s_add_u32 m0, s59, 17408
    s_nop 0
    buffer_load_dwordx4 v240, s[40:43], s77 offen lds
    s_add_u32 s77, s77, 65536
    buffer_load_dword v14, v15, s[28:31], s71 offen sc1
    s_add_u32 m0, s59, 18432
    s_nop 0
    buffer_load_dwordx4 v240, s[40:43], s76 offen lds
    s_add_u32 s76, s76, 65536
    s_add_u32 m0, s59, 19456
    s_nop 0
    buffer_load_dwordx4 v240, s[40:43], s77 offen lds
    s_add_u32 s77, s77, 65536
    s_add_u32 m0, s59, 20480
    s_nop 0
    buffer_load_dwordx4 v240, s[40:43], s76 offen lds
    s_add_u32 s76, s76, 65536
    s_add_u32 m0, s59, 21504
    s_nop 0
    buffer_load_dwordx4 v240, s[40:43], s77 offen lds
    s_add_u32 s77, s77, 65536
    s_add_u32 m0, s59, 22528
    s_nop 0
    buffer_load_dwordx4 v240, s[40:43], s76 offen lds
    s_add_u32 s76, s76, 65536
    s_add_u32 m0, s59, 23552
    s_nop 0
    buffer_load_dwordx4 v240, s[40:43], s77 offen lds
    s_add_u32 s77, s77, 65536
    s_add_u32 m0, s59, 24576
    s_nop 0
    buffer_load_dwordx4 v240, s[40:43], s76 offen lds
    s_add_u32 s76, s76, 65536
    s_add_u32 m0, s59, 25600
    s_nop 0
    buffer_load_dwordx4 v240, s[40:43], s77 offen lds
    s_add_u32 s77, s77, 65536
    s_add_u32 m0, s59, 26624
    s_nop 0
    buffer_load_dwordx4 v240, s[40:43], s76 offen lds
    s_add_u32 s76, s76, 65536
    s_add_u32 m0, s59, 27648
    s_nop 0
    buffer_load_dwordx4 v240, s[40:43], s77 offen lds
    s_add_u32 s77, s77, 65536
    s_mul_i32 s60, s10, 448
    s_and_b32 s61, s56, 3
    s_mul_i32 s61, s61, 56
    s_add_u32 s60, s60, s61
    s_add_u32 s60, s60, 224
    v_min_u32 v13, 55, v2
    v_add_u32 v13, s60, v13
    v_lshlrev_b32 v13, 12, v13
    s_lshl_b32 s60, s57, 7
    buffer_load_dword v11, v13, s[40:43], s60 offen
    s_cmp_ge_u32 s2, 224
    s_cbranch_scc1 L_skipG1
    s_mov_b32 s61, 0
    s_waitcnt vmcnt(11)
    v_cmp_eq_u32 vcc, -1, v14
    s_nop 4
    s_cbranch_vccz L_pr31_ok
L_pr31:
    buffer_load_dword v14, v15, s[28:31], s71 offen sc1
    s_add_u32 s61, s61, 1
    s_waitcnt vmcnt(0)
    v_cmp_eq_u32 vcc, -1, v14
    s_nop 4
    s_cbranch_vccz L_pr31_ok
    s_cmp_lt_u32 s61, 131072
    s_cbranch_scc1 L_pr31
L_pr31_ok:
    s_lshr_b32 s61, s10, 1
    s_lshl_b32 s72, s55, 6
    s_lshl_b32 s64, s61, 5
    s_add_u32 s72, s72, s64
    s_lshl_b32 s64, s72, 1
    v_lshlrev_b32 v15, 3, v6
    v_add_u32_e64 v15, s64, v15
    global_load_dwordx2 v[20:21], v15, s[48:49] offset:0
    global_load_dwordx2 v[22:23], v15, s[48:49] offset:16
    global_load_dwordx2 v[24:25], v15, s[48:49] offset:32
    global_load_dwordx2 v[26:27], v15, s[48:49] offset:48
    s_waitcnt lgkmcnt(0)
    s_barrier
    s_mov_b32 s73, s71
    buffer_load_dwordx4 v[128:131], v8, s[28:31], s73 offen sc1
    buffer_load_dwordx4 v[132:135], v9, s[28:31], s73 offen sc1
    s_nop 0
    s_add_u32 s73, s73, 16384
    buffer_load_dwordx4 v[136:139], v8, s[28:31], s73 offen sc1
    buffer_load_dwordx4 v[140:143], v9, s[28:31], s73 offen sc1
    s_add_u32 s73, s73, 16384
    buffer_load_dwordx4 v[144:147], v8, s[28:31], s73 offen sc1
    buffer_load_dwordx4 v[148:151], v9, s[28:31], s73 offen sc1
    s_add_u32 s73, s73, 16384
    buffer_load_dwordx4 v[152:155], v8, s[28:31], s73 offen sc1
    buffer_load_dwordx4 v[156:159], v9, s[28:31], s73 offen sc1
    s_add_u32 s73, s73, 16384
    buffer_load_dwordx4 v[160:163], v8, s[28:31], s73 offen sc1
    buffer_load_dwordx4 v[164:167], v9, s[28:31], s73 offen sc1
    s_add_u32 s73, s73, 16384
    s_waitcnt vmcnt(8)
    v_max3_u32 v12, v128, v129, v130
    v_max3_u32 v12, v12, v131, v132
    v_max3_u32 v12, v12, v133, v134
    v_max_u32 v12, v12, v135
    v_cmp_eq_u32 vcc, -1, v12
    s_nop 4
    s_cbranch_vccnz L_rt32
L_rb33:
    v_mfma_f32_32x32x16_bf16 v[64:79], a[0:3], v[128:131], 0
    buffer_load_dwordx4 v[168:171], v8, s[28:31], s73 offen sc1
    v_mfma_f32_32x32x16_bf16 v[80:95], a[0:3], v[132:135], 0
    buffer_load_dwordx4 v[172:175], v9, s[28:31], s73 offen sc1
    s_add_u32 s73, s73, 16384
    s_waitcnt vmcnt(8)
    v_max3_u32 v12, v136, v137, v138
    v_max3_u32 v12, v12, v139, v140
    v_max3_u32 v12, v12, v141, v142
    v_max_u32 v12, v12, v143
    v_cmp_eq_u32 vcc, -1, v12
    v_mfma_f32_32x32x16_bf16 v[96:111], a[4:7], v[128:131], 0
    v_mfma_f32_32x32x16_bf16 v[112:127], a[4:7], v[132:135], 0
    s_nop 2
    s_cbranch_vccnz L_rt34
L_rb35:
    v_mfma_f32_32x32x16_bf16 v[64:79], a[8:11], v[136:139], v[64:79]
    buffer_load_dwordx4 v[176:179], v8, s[28:31], s73 offen sc1
    v_mfma_f32_32x32x16_bf16 v[80:95], a[8:11], v[140:143], v[80:95]
    buffer_load_dwordx4 v[180:183], v9, s[28:31], s73 offen sc1
    s_add_u32 s73, s73, 16384
    s_waitcnt vmcnt(8)
    v_max3_u32 v12, v144, v145, v146
    v_max3_u32 v12, v12, v147, v148
    v_max3_u32 v12, v12, v149, v150
    v_max_u32 v12, v12, v151
    v_cmp_eq_u32 vcc, -1, v12
    v_mfma_f32_32x32x16_bf16 v[96:111], a[12:15], v[136:139], v[96:111]
    v_mfma_f32_32x32x16_bf16 v[112:127], a[12:15], v[140:143], v[112:127]
    s_nop 2
    s_cbranch_vccnz L_rt36
L_rb37:
    v_mfma_f32_32x32x16_bf16 v[64:79], a[16:19], v[144:147], v[64:79]
    buffer_load_dwordx4 v[184:187], v8, s[28:31], s73 offen sc1
    v_mfma_f32_32x32x16_bf16 v[80:95], a[16:19], v[148:151], v[80:95]
    buffer_load_dwordx4 v[188:191], v9, s[28:31], s73 offen sc1
    s_add_u32 s73, s73, 16384
    s_waitcnt vmcnt(8)
    v_max3_u32 v12, v152, v153, v154
    v_max3_u32 v12, v12, v155, v156
    v_max3_u32 v12, v12, v157, v158
    v_max_u32 v12, v12, v159
    v_cmp_eq_u32 vcc, -1, v12
    v_mfma_f32_32x32x16_bf16 v[96:111], a[20:23], v[144:147], v[96:111]
    v_mfma_f32_32x32x16_bf16 v[112:127], a[20:23], v[148:151], v[112:127]
    v_lshlrev_b32_e64 v28, 16, v20
    v_and_b32 v29, 0xffff0000, v20
    v_lshlrev_b32_e64 v30, 16, v21
    v_and_b32 v31, 0xffff0000, v21
    s_nop 2
    s_cbranch_vccnz L_rt38
L_rb39:
    v_mfma_f32_32x32x16_bf16 v[64:79], a[24:27], v[152:155], v[64:79]
    buffer_load_dwordx4 v[192:195], v8, s[28:31], s73 offen sc1
    v_mfma_f32_32x32x16_bf16 v[80:95], a[24:27], v[156:159], v[80:95]
    buffer_load_dwordx4 v[196:199], v9, s[28:31], s73 offen sc1
    s_add_u32 s73, s73, 16384
    s_waitcnt vmcnt(8)
    v_max3_u32 v12, v160, v161, v162
    v_max3_u32 v12, v12, v163, v164
    v_max3_u32 v12, v12, v165, v166
    v_max_u32 v12, v12, v167
    v_cmp_eq_u32 vcc, -1, v12
    v_mfma_f32_32x32x16_bf16 v[96:111], a[28:31], v[152:155], v[96:111]
    v_mfma_f32_32x32x16_bf16 v[112:127], a[28:31], v[156:159], v[112:127]
    v_lshlrev_b32 v32, 16, v22
    v_and_b32 v33, 0xffff0000, v22
    v_lshlrev_b32_e64 v34, 16, v23
    v_and_b32 v35, 0xffff0000, v23
    s_nop 2
    s_cbranch_vccnz L_rt40
L_rb41:
    v_mfma_f32_32x32x16_bf16 v[64:79], a[32:35], v[160:163], v[64:79]
    buffer_load_dwordx4 v[200:203], v8, s[28:31], s73 offen sc1
    v_mfma_f32_32x32x16_bf16 v[80:95], a[32:35], v[164:167], v[80:95]
    buffer_load_dwordx4 v[204:207], v9, s[28:31], s73 offen sc1
    s_add_u32 s73, s73, 16384
    s_waitcnt vmcnt(8)
    v_max3_u32 v12, v168, v169, v170
    v_max3_u32 v12, v12, v171, v172
    v_max3_u32 v12, v12, v173, v174
    v_max_u32 v12, v12, v175
    v_cmp_eq_u32 vcc, -1, v12
    v_mfma_f32_32x32x16_bf16 v[96:111], a[36:39], v[160:163], v[96:111]
    v_mfma_f32_32x32x16_bf16 v[112:127], a[36:39], v[164:167], v[112:127]
    v_lshlrev_b32 v36, 16, v24
    v_and_b32 v37, 0xffff0000, v24
    v_lshlrev_b32_e64 v38, 16, v25
    v_and_b32 v39, 0xffff0000, v25
    s_nop 2
    s_cbranch_vccnz L_rt42
L_rb43:
    v_mfma_f32_32x32x16_bf16 v[64:79], a[40:43], v[168:171], v[64:79]
    buffer_load_dwordx4 v[208:211], v8, s[28:31], s73 offen sc1
    v_mfma_f32_32x32x16_bf16 v[80:95], a[40:43], v[172:175], v[80:95]
    buffer_load_dwordx4 v[212:215], v9, s[28:31], s73 offen sc1
    s_add_u32 s73, s73, 16384
    s_waitcnt vmcnt(8)
    v_max3_u32 v12, v176, v177, v178
    v_max3_u32 v12, v12, v179, v180
    v_max3_u32 v12, v12, v181, v182
    v_max_u32 v12, v12, v183
    v_cmp_eq_u32 vcc, -1, v12
    v_mfma_f32_32x32x16_bf16 v[96:111], a[44:47], v[168:171], v[96:111]
    v_mfma_f32_32x32x16_bf16 v[112:127], a[44:47], v[172:175], v[112:127]
    v_lshlrev_b32 v40, 16, v26
    v_and_b32 v41, 0xffff0000, v26
    v_lshlrev_b32_e64 v42, 16, v27
    v_and_b32 v43, 0xffff0000, v27
    s_nop 2
    s_cbranch_vccnz L_rt44
L_rb45:
    v_mfma_f32_32x32x16_bf16 v[64:79], a[48:51], v[176:179], v[64:79]
    buffer_load_dwordx4 v[216:219], v8, s[28:31], s73 offen sc1
    v_mfma_f32_32x32x16_bf16 v[80:95], a[48:51], v[180:183], v[80:95]
    buffer_load_dwordx4 v[220:223], v9, s[28:31], s73 offen sc1
    s_add_u32 s73, s73, 16384
    s_waitcnt vmcnt(8)
    v_max3_u32 v12, v184, v185, v186
    v_max3_u32 v12, v12, v187, v188
    v_max3_u32 v12, v12, v189, v190
    v_max_u32 v12, v12, v191
    v_cmp_eq_u32 vcc, -1, v12
    v_mfma_f32_32x32x16_bf16 v[96:111], a[52:55], v[176:179], v[96:111]
    v_mfma_f32_32x32x16_bf16 v[112:127], a[52:55], v[180:183], v[112:127]
    s_nop 2
    s_cbranch_vccnz L_rt46
L_rb47:
    v_mfma_f32_32x32x16_bf16 v[64:79], a[56:59], v[184:187], v[64:79]
    buffer_load_dwordx4 v[224:227], v8, s[28:31], s73 offen sc1
    v_mfma_f32_32x32x16_bf16 v[80:95], a[56:59], v[188:191], v[80:95]
    buffer_load_dwordx4 v[228:231], v9, s[28:31], s73 offen sc1
    s_add_u32 s73, s73, 16384
    s_waitcnt vmcnt(8)
    v_max3_u32 v12, v192, v193, v194
    v_max3_u32 v12, v12, v195, v196
    v_max3_u32 v12, v12, v197, v198
    v_max_u32 v12, v12, v199
    v_cmp_eq_u32 vcc, -1, v12
    v_mfma_f32_32x32x16_bf16 v[96:111], a[60:63], v[184:187], v[96:111]
    v_mfma_f32_32x32x16_bf16 v[112:127], a[60:63], v[188:191], v[112:127]
    s_nop 2
    s_cbranch_vccnz L_rt48
L_rb49:
    v_mfma_f32_32x32x16_bf16 v[64:79], a[64:67], v[192:195], v[64:79]
    buffer_load_dwordx4 v[232:235], v8, s[28:31], s73 offen sc1
    v_mfma_f32_32x32x16_bf16 v[80:95], a[64:67], v[196:199], v[80:95]
    buffer_load_dwordx4 v[236:239], v9, s[28:31], s73 offen sc1
    s_add_u32 s73, s73, 16384
    s_waitcnt vmcnt(8)
    v_max3_u32 v12, v200, v201, v202
    v_max3_u32 v12, v12, v203, v204
    v_max3_u32 v12, v12, v205, v206
    v_max_u32 v12, v12, v207
    v_cmp_eq_u32 vcc, -1, v12
    v_mfma_f32_32x32x16_bf16 v[96:111], a[68:71], v[192:195], v[96:111]
    v_mfma_f32_32x32x16_bf16 v[112:127], a[68:71], v[196:199], v[112:127]
    s_nop 2
    s_cbranch_vccnz L_rt50
L_rb51:
    v_mfma_f32_32x32x16_bf16 v[64:79], a[72:75], v[200:203], v[64:79]
    buffer_load_dwordx4 v[128:131], v8, s[28:31], s73 offen sc1
    v_mfma_f32_32x32x16_bf16 v[80:95], a[72:75], v[204:207], v[80:95]
    buffer_load_dwordx4 v[132:135], v9, s[28:31], s73 offen sc1
    s_add_u32 s73, s73, 16384
    s_waitcnt vmcnt(8)
    v_max3_u32 v12, v208, v209, v210
    v_max3_u32 v12, v12, v211, v212
    v_max3_u32 v12, v12, v213, v214
    v_max_u32 v12, v12, v215
    v_cmp_eq_u32 vcc, -1, v12
    v_mfma_f32_32x32x16_bf16 v[96:111], a[76:79], v[200:203], v[96:111]
    v_mfma_f32_32x32x16_bf16 v[112:127], a[76:79], v[204:207], v[112:127]
    s_nop 2
    s_cbranch_vccnz L_rt52
L_rb53:
    v_mfma_f32_32x32x16_bf16 v[64:79], a[80:83], v[208:211], v[64:79]
    buffer_load_dwordx4 v[136:139], v8, s[28:31], s73 offen sc1
    v_mfma_f32_32x32x16_bf16 v[80:95], a[80:83], v[212:215], v[80:95]
    buffer_load_dwordx4 v[140:143], v9, s[28:31], s73 offen sc1
    s_add_u32 s73, s73, 16384
    s_waitcnt vmcnt(8)
    v_max3_u32 v12, v216, v217, v218
    v_max3_u32 v12, v12, v219, v220
    v_max3_u32 v12, v12, v221, v222
    v_max_u32 v12, v12, v223
    v_cmp_eq_u32 vcc, -1, v12
    v_mfma_f32_32x32x16_bf16 v[96:111], a[84:87], v[208:211], v[96:111]
    v_mfma_f32_32x32x16_bf16 v[112:127], a[84:87], v[212:215], v[112:127]
    s_nop 2
    s_cbranch_vccnz L_rt54
L_rb55:
    v_mfma_f32_32x32x16_bf16 v[64:79], a[88:91], v[216:219], v[64:79]
    buffer_load_dwordx4 v[144:147], v8, s[28:31], s73 offen sc1
    v_mfma_f32_32x32x16_bf16 v[80:95], a[88:91], v[220:223], v[80:95]
    buffer_load_dwordx4 v[148:151], v9, s[28:31], s73 offen sc1
    s_add_u32 s73, s73, 16384
    s_waitcnt vmcnt(8)
    v_max3_u32 v12, v224, v225, v226
    v_max3_u32 v12, v12, v227, v228
    v_max3_u32 v12, v12, v229, v230
    v_max_u32 v12, v12, v231
    v_cmp_eq_u32 vcc, -1, v12
    v_mfma_f32_32x32x16_bf16 v[96:111], a[92:95], v[216:219], v[96:111]
    v_mfma_f32_32x32x16_bf16 v[112:127], a[92:95], v[220:223], v[112:127]
    s_nop 2
    s_cbranch_vccnz L_rt56
L_rb57:
    v_mfma_f32_32x32x16_bf16 v[64:79], a[96:99], v[224:227], v[64:79]
    buffer_load_dwordx4 v[152:155], v8, s[28:31], s73 offen sc1
    v_mfma_f32_32x32x16_bf16 v[80:95], a[96:99], v[228:231], v[80:95]
    buffer_load_dwordx4 v[156:159], v9, s[28:31], s73 offen sc1
    s_add_u32 s73, s73, 16384
    s_waitcnt vmcnt(8)
    v_max3_u32 v12, v232, v233, v234
    v_max3_u32 v12, v12, v235, v236
    v_max3_u32 v12, v12, v237, v238
    v_max_u32 v12, v12, v239
    v_cmp_eq_u32 vcc, -1, v12
    v_mfma_f32_32x32x16_bf16 v[96:111], a[100:103], v[224:227], v[96:111]
    v_mfma_f32_32x32x16_bf16 v[112:127], a[100:103], v[228:231], v[112:127]
    s_nop 2
    s_cbranch_vccnz L_rt58
L_rb59:
    v_mfma_f32_32x32x16_bf16 v[64:79], a[104:107], v[232:235], v[64:79]
    buffer_load_dwordx4 v[160:163], v8, s[28:31], s73 offen sc1
    v_mfma_f32_32x32x16_bf16 v[80:95], a[104:107], v[236:239], v[80:95]
    buffer_load_dwordx4 v[164:167], v9, s[28:31], s73 offen sc1
    s_add_u32 s73, s73, 16384
    s_waitcnt vmcnt(8)
    v_max3_u32 v12, v128, v129, v130
    v_max3_u32 v12, v12, v131, v132
    v_max3_u32 v12, v12, v133, v134
    v_max_u32 v12, v12, v135
    v_cmp_eq_u32 vcc, -1, v12
    v_mfma_f32_32x32x16_bf16 v[96:111], a[108:111], v[232:235], v[96:111]
    v_mfma_f32_32x32x16_bf16 v[112:127], a[108:111], v[236:239], v[112:127]
    s_nop 2
    s_cbranch_vccnz L_rt60
L_rb61:
    v_mfma_f32_32x32x16_bf16 v[64:79], a[112:115], v[128:131], v[64:79]
    buffer_load_dwordx4 v[168:171], v8, s[28:31], s73 offen sc1
    v_mfma_f32_32x32x16_bf16 v[80:95], a[112:115], v[132:135], v[80:95]
    buffer_load_dwordx4 v[172:175], v9, s[28:31], s73 offen sc1
    s_add_u32 s73, s73, 16384
    s_waitcnt vmcnt(8)
    v_max3_u32 v12, v136, v137, v138
    v_max3_u32 v12, v12, v139, v140
    v_max3_u32 v12, v12, v141, v142
    v_max_u32 v12, v12, v143
    v_cmp_eq_u32 vcc, -1, v12
    v_mfma_f32_32x32x16_bf16 v[96:111], a[116:119], v[128:131], v[96:111]
    v_mfma_f32_32x32x16_bf16 v[112:127], a[116:119], v[132:135], v[112:127]
    s_nop 2
    s_cbranch_vccnz L_rt62
L_rb63:
    v_mfma_f32_32x32x16_bf16 v[64:79], a[120:123], v[136:139], v[64:79]
    buffer_load_dwordx4 v[176:179], v8, s[28:31], s73 offen sc1
    v_mfma_f32_32x32x16_bf16 v[80:95], a[120:123], v[140:143], v[80:95]
    buffer_load_dwordx4 v[180:183], v9, s[28:31], s73 offen sc1
    s_add_u32 s73, s73, 16384
    s_waitcnt vmcnt(8)
    v_max3_u32 v12, v144, v145, v146
    v_max3_u32 v12, v12, v147, v148
    v_max3_u32 v12, v12, v149, v150
    v_max_u32 v12, v12, v151
    v_cmp_eq_u32 vcc, -1, v12
    v_mfma_f32_32x32x16_bf16 v[96:111], a[124:127], v[136:139], v[96:111]
    v_mfma_f32_32x32x16_bf16 v[112:127], a[124:127], v[140:143], v[112:127]
    s_nop 2
    s_cbranch_vccnz L_rt64
L_rb65:
    v_mfma_f32_32x32x16_bf16 v[64:79], a[128:131], v[144:147], v[64:79]
    buffer_load_dwordx4 v[184:187], v8, s[28:31], s73 offen sc1
    v_mfma_f32_32x32x16_bf16 v[80:95], a[128:131], v[148:151], v[80:95]
    buffer_load_dwordx4 v[188:191], v9, s[28:31], s73 offen sc1
    s_add_u32 s73, s73, 16384
    s_waitcnt vmcnt(8)
    v_max3_u32 v12, v152, v153, v154
    v_max3_u32 v12, v12, v155, v156
    v_max3_u32 v12, v12, v157, v158
    v_max_u32 v12, v12, v159
    v_cmp_eq_u32 vcc, -1, v12
    v_mfma_f32_32x32x16_bf16 v[96:111], a[132:135], v[144:147], v[96:111]
    v_mfma_f32_32x32x16_bf16 v[112:127], a[132:135], v[148:151], v[112:127]
    s_nop 2
    s_cbranch_vccnz L_rt66
L_rb67:
    v_mfma_f32_32x32x16_bf16 v[64:79], a[136:139], v[152:155], v[64:79]
    buffer_load_dwordx4 v[192:195], v8, s[28:31], s73 offen sc1
    v_mfma_f32_32x32x16_bf16 v[80:95], a[136:139], v[156:159], v[80:95]
    buffer_load_dwordx4 v[196:199], v9, s[28:31], s73 offen sc1
    s_add_u32 s73, s73, 16384
    s_waitcnt vmcnt(8)
    v_max3_u32 v12, v160, v161, v162
    v_max3_u32 v12, v12, v163, v164
    v_max3_u32 v12, v12, v165, v166
    v_max_u32 v12, v12, v167
    v_cmp_eq_u32 vcc, -1, v12
    v_mfma_f32_32x32x16_bf16 v[96:111], a[140:143], v[152:155], v[96:111]
    v_mfma_f32_32x32x16_bf16 v[112:127], a[140:143], v[156:159], v[112:127]
    s_nop 2
    s_cbranch_vccnz L_rt68
L_rb69:
    v_mfma_f32_32x32x16_bf16 v[64:79], a[144:147], v[160:163], v[64:79]
    buffer_load_dwordx4 v[200:203], v8, s[28:31], s73 offen sc1
    v_mfma_f32_32x32x16_bf16 v[80:95], a[144:147], v[164:167], v[80:95]
    buffer_load_dwordx4 v[204:207], v9, s[28:31], s73 offen sc1
    s_add_u32 s73, s73, 16384
    s_waitcnt vmcnt(8)
    v_max3_u32 v12, v168, v169, v170
    v_max3_u32 v12, v12, v171, v172
    v_max3_u32 v12, v12, v173, v174
    v_max_u32 v12, v12, v175
    v_cmp_eq_u32 vcc, -1, v12
    v_mfma_f32_32x32x16_bf16 v[96:111], a[148:151], v[160:163], v[96:111]
    v_mfma_f32_32x32x16_bf16 v[112:127], a[148:151], v[164:167], v[112:127]
    s_nop 2
    s_cbranch_vccnz L_rt70
L_rb71:
    v_mfma_f32_32x32x16_bf16 v[64:79], a[152:155], v[168:171], v[64:79]
    buffer_load_dwordx4 v[208:211], v8, s[28:31], s73 offen sc1
    v_mfma_f32_32x32x16_bf16 v[80:95], a[152:155], v[172:175], v[80:95]
    buffer_load_dwordx4 v[212:215], v9, s[28:31], s73 offen sc1
    s_add_u32 s73, s73, 16384
    s_waitcnt vmcnt(8)
    v_max3_u32 v12, v176, v177, v178
    v_max3_u32 v12, v12, v179, v180
    v_max3_u32 v12, v12, v181, v182
    v_max_u32 v12, v12, v183
    v_cmp_eq_u32 vcc, -1, v12
    v_mfma_f32_32x32x16_bf16 v[96:111], a[156:159], v[168:171], v[96:111]
    v_mfma_f32_32x32x16_bf16 v[112:127], a[156:159], v[172:175], v[112:127]
    s_nop 2
    s_cbranch_vccnz L_rt72
L_rb73:
    v_mfma_f32_32x32x16_bf16 v[64:79], a[160:163], v[176:179], v[64:79]
    buffer_load_dwordx4 v[216:219], v8, s[28:31], s73 offen sc1
    v_mfma_f32_32x32x16_bf16 v[80:95], a[160:163], v[180:183], v[80:95]
    buffer_load_dwordx4 v[220:223], v9, s[28:31], s73 offen sc1
    s_add_u32 s73, s73, 16384
    s_waitcnt vmcnt(8)
    v_max3_u32 v12, v184, v185, v186
    v_max3_u32 v12, v12, v187, v188
    v_max3_u32 v12, v12, v189, v190
    v_max_u32 v12, v12, v191
    v_cmp_eq_u32 vcc, -1, v12
    v_mfma_f32_32x32x16_bf16 v[96:111], a[164:167], v[176:179], v[96:111]
    v_mfma_f32_32x32x16_bf16 v[112:127], a[164:167], v[180:183], v[112:127]
    s_nop 2
    s_cbranch_vccnz L_rt74
L_rb75:
    v_mfma_f32_32x32x16_bf16 v[64:79], a[168:171], v[184:187], v[64:79]
    buffer_load_dwordx4 v[224:227], v8, s[28:31], s73 offen sc1
    v_mfma_f32_32x32x16_bf16 v[80:95], a[168:171], v[188:191], v[80:95]
    buffer_load_dwordx4 v[228:231], v9, s[28:31], s73 offen sc1
    s_add_u32 s73, s73, 16384
    s_waitcnt vmcnt(8)
    v_max3_u32 v12, v192, v193, v194
    v_max3_u32 v12, v12, v195, v196
    v_max3_u32 v12, v12, v197, v198
    v_max_u32 v12, v12, v199
    v_cmp_eq_u32 vcc, -1, v12
    v_mfma_f32_32x32x16_bf16 v[96:111], a[172:175], v[184:187], v[96:111]
    v_mfma_f32_32x32x16_bf16 v[112:127], a[172:175], v[188:191], v[112:127]
    s_nop 2
    s_cbranch_vccnz L_rt76
L_rb77:
    v_mfma_f32_32x32x16_bf16 v[64:79], a[176:179], v[192:195], v[64:79]
    buffer_load_dwordx4 v[232:235], v8, s[28:31], s73 offen sc1
    v_mfma_f32_32x32x16_bf16 v[80:95], a[176:179], v[196:199], v[80:95]
    buffer_load_dwordx4 v[236:239], v9, s[28:31], s73 offen sc1
    s_add_u32 s73, s73, 16384
    s_waitcnt vmcnt(8)
    v_max3_u32 v12, v200, v201, v202
    v_max3_u32 v12, v12, v203, v204
    v_max3_u32 v12, v12, v205, v206
    v_max_u32 v12, v12, v207
    v_cmp_eq_u32 vcc, -1, v12
    v_mfma_f32_32x32x16_bf16 v[96:111], a[180:183], v[192:195], v[96:111]
    v_mfma_f32_32x32x16_bf16 v[112:127], a[180:183], v[196:199], v[112:127]
    s_nop 2
    s_cbranch_vccnz L_rt78
L_rb79:
    v_mfma_f32_32x32x16_bf16 v[64:79], a[184:187], v[200:203], v[64:79]
    buffer_load_dwordx4 v[128:131], v8, s[28:31], s73 offen sc1
    v_mfma_f32_32x32x16_bf16 v[80:95], a[184:187], v[204:207], v[80:95]
    buffer_load_dwordx4 v[132:135], v9, s[28:31], s73 offen sc1
    s_add_u32 s73, s73, 16384
    s_waitcnt vmcnt(8)
    v_max3_u32 v12, v208, v209, v210
    v_max3_u32 v12, v12, v211, v212
    v_max3_u32 v12, v12, v213, v214
    v_max_u32 v12, v12, v215
    v_cmp_eq_u32 vcc, -1, v12
    v_mfma_f32_32x32x16_bf16 v[96:111], a[188:191], v[200:203], v[96:111]
    v_mfma_f32_32x32x16_bf16 v[112:127], a[188:191], v[204:207], v[112:127]
    s_nop 2
    s_cbranch_vccnz L_rt80
L_rb81:
    v_mfma_f32_32x32x16_bf16 v[64:79], a[192:195], v[208:211], v[64:79]
    buffer_load_dwordx4 v[136:139], v8, s[28:31], s73 offen sc1
    v_mfma_f32_32x32x16_bf16 v[80:95], a[192:195], v[212:215], v[80:95]
    buffer_load_dwordx4 v[140:143], v9, s[28:31], s73 offen sc1
    s_add_u32 s73, s73, 16384
    s_waitcnt vmcnt(8)
    v_max3_u32 v12, v216, v217, v218
    v_max3_u32 v12, v12, v219, v220
    v_max3_u32 v12, v12, v221, v222
    v_max_u32 v12, v12, v223
    v_cmp_eq_u32 vcc, -1, v12
    v_mfma_f32_32x32x16_bf16 v[96:111], a[196:199], v[208:211], v[96:111]
    v_mfma_f32_32x32x16_bf16 v[112:127], a[196:199], v[212:215], v[112:127]
    s_nop 2
    s_cbranch_vccnz L_rt82
L_rb83:
    v_mfma_f32_32x32x16_bf16 v[64:79], a[200:203], v[216:219], v[64:79]
    buffer_load_dwordx4 v[144:147], v8, s[28:31], s73 offen sc1
    v_mfma_f32_32x32x16_bf16 v[80:95], a[200:203], v[220:223], v[80:95]
    buffer_load_dwordx4 v[148:151], v9, s[28:31], s73 offen sc1
    s_add_u32 s73, s73, 16384
    s_waitcnt vmcnt(8)
    v_max3_u32 v12, v224, v225, v226
    v_max3_u32 v12, v12, v227, v228
    v_max3_u32 v12, v12, v229, v230
    v_max_u32 v12, v12, v231
    v_cmp_eq_u32 vcc, -1, v12
    v_mfma_f32_32x32x16_bf16 v[96:111], a[204:207], v[216:219], v[96:111]
    v_mfma_f32_32x32x16_bf16 v[112:127], a[204:207], v[220:223], v[112:127]
    s_nop 2
    s_cbranch_vccnz L_rt84
L_rb85:
    v_mfma_f32_32x32x16_bf16 v[64:79], a[208:211], v[224:227], v[64:79]
    buffer_load_dwordx4 v[152:155], v8, s[28:31], s73 offen sc1
    v_mfma_f32_32x32x16_bf16 v[80:95], a[208:211], v[228:231], v[80:95]
    buffer_load_dwordx4 v[156:159], v9, s[28:31], s73 offen sc1
    s_add_u32 s73, s73, 16384
    s_waitcnt vmcnt(8)
    v_max3_u32 v12, v232, v233, v234
    v_max3_u32 v12, v12, v235, v236
    v_max3_u32 v12, v12, v237, v238
    v_max_u32 v12, v12, v239
    v_cmp_eq_u32 vcc, -1, v12
    v_mfma_f32_32x32x16_bf16 v[96:111], a[212:215], v[224:227], v[96:111]
    v_mfma_f32_32x32x16_bf16 v[112:127], a[212:215], v[228:231], v[112:127]
    s_nop 2
    s_cbranch_vccnz L_rt86
L_rb87:
    v_mfma_f32_32x32x16_bf16 v[64:79], a[216:219], v[232:235], v[64:79]
    v_mfma_f32_32x32x16_bf16 v[80:95], a[216:219], v[236:239], v[80:95]
    s_waitcnt vmcnt(6)
    v_max3_u32 v12, v128, v129, v130
    v_max3_u32 v12, v12, v131, v132
    v_max3_u32 v12, v12, v133, v134
    v_max_u32 v12, v12, v135
    v_cmp_eq_u32 vcc, -1, v12
    v_mfma_f32_32x32x16_bf16 v[96:111], a[220:223], v[232:235], v[96:111]
    v_mfma_f32_32x32x16_bf16 v[112:127], a[220:223], v[236:239], v[112:127]
    s_nop 2
    s_cbranch_vccnz L_rt88
L_rb89:
    v_mfma_f32_32x32x16_bf16 v[64:79], a[224:227], v[128:131], v[64:79]
    v_mfma_f32_32x32x16_bf16 v[80:95], a[224:227], v[132:135], v[80:95]
    s_waitcnt vmcnt(4)
    v_max3_u32 v12, v136, v137, v138
    v_max3_u32 v12, v12, v139, v140
    v_max3_u32 v12, v12, v141, v142
    v_max_u32 v12, v12, v143
    v_cmp_eq_u32 vcc, -1, v12
    v_mfma_f32_32x32x16_bf16 v[96:111], a[228:231], v[128:131], v[96:111]
    v_mfma_f32_32x32x16_bf16 v[112:127], a[228:231], v[132:135], v[112:127]
    s_nop 2
    s_cbranch_vccnz L_rt90
L_rb91:
    v_mfma_f32_32x32x16_bf16 v[64:79], a[232:235], v[136:139], v[64:79]
    v_mfma_f32_32x32x16_bf16 v[80:95], a[232:235], v[140:143], v[80:95]
    s_waitcnt vmcnt(2)
    v_max3_u32 v12, v144, v145, v146
    v_max3_u32 v12, v12, v147, v148
    v_max3_u32 v12, v12, v149, v150
    v_max_u32 v12, v12, v151
    v_cmp_eq_u32 vcc, -1, v12
    v_mfma_f32_32x32x16_bf16 v[96:111], a[236:239], v[136:139], v[96:111]
    v_mfma_f32_32x32x16_bf16 v[112:127], a[236:239], v[140:143], v[112:127]
    s_nop 2
    s_cbranch_vccnz L_rt92
L_rb93:
    v_mfma_f32_32x32x16_bf16 v[64:79], a[240:243], v[144:147], v[64:79]
    v_mfma_f32_32x32x16_bf16 v[80:95], a[240:243], v[148:151], v[80:95]
    s_waitcnt vmcnt(0)
    v_max3_u32 v12, v152, v153, v154
    v_max3_u32 v12, v12, v155, v156
    v_max3_u32 v12, v12, v157, v158
    v_max_u32 v12, v12, v159
    v_cmp_eq_u32 vcc, -1, v12
    v_mfma_f32_32x32x16_bf16 v[96:111], a[244:247], v[144:147], v[96:111]
    v_mfma_f32_32x32x16_bf16 v[112:127], a[244:247], v[148:151], v[112:127]
    s_nop 2
    s_cbranch_vccnz L_rt94
L_rb95:
    v_mfma_f32_32x32x16_bf16 v[64:79], a[248:251], v[152:155], v[64:79]
    v_mfma_f32_32x32x16_bf16 v[80:95], a[248:251], v[156:159], v[80:95]
    v_mfma_f32_32x32x16_bf16 v[96:111], a[252:255], v[152:155], v[96:111]
    v_mfma_f32_32x32x16_bf16 v[112:127], a[252:255], v[156:159], v[112:127]
    v_lshlrev_b32 v13, 4, v2
    s_xor_b32 s60, s10, 1
    s_mul_i32 s60, s60, 12288
    s_add_u32 s60, s60, 0
    v_add_u32 v14, s60, v13
    s_nop 4
    ds_write_b128 v14, v[80:83] offset:0
    ds_write_b128 v14, v[84:87] offset:1024
    ds_write_b128 v14, v[88:91] offset:2048
    ds_write_b128 v14, v[92:95] offset:3072
    s_xor_b32 s60, s10, 2
    s_mul_i32 s60, s60, 12288
    s_add_u32 s60, s60, 4096
    v_add_u32 v14, s60, v13
    ds_write_b128 v14, v[96:99] offset:0
    ds_write_b128 v14, v[100:103] offset:1024
    ds_write_b128 v14, v[104:107] offset:2048
    ds_write_b128 v14, v[108:111] offset:3072
    s_xor_b32 s60, s10, 3
    s_mul_i32 s60, s60, 12288
    s_add_u32 s60, s60, 8192
    v_add_u32 v14, s60, v13
    ds_write_b128 v14, v[112:115] offset:0
    ds_write_b128 v14, v[116:119] offset:1024
    ds_write_b128 v14, v[120:123] offset:2048
    ds_write_b128 v14, v[124:127] offset:3072
    ds_read_b64_tr_b16 a[0:1], v246 offset:0
    ds_read_b64_tr_b16 a[2:3], v246 offset:1024
    ds_read_b64_tr_b16 a[4:5], v247 offset:0
    ds_read_b64_tr_b16 a[6:7], v247 offset:1024
    ds_read_b64_tr_b16 a[8:9], v246 offset:2048
    ds_read_b64_tr_b16 a[10:11], v246 offset:3072
    ds_read_b64_tr_b16 a[12:13], v247 offset:2048
    ds_read_b64_tr_b16 a[14:15], v247 offset:3072
    ds_read_b64_tr_b16 a[16:17], v246 offset:4096
    ds_read_b64_tr_b16 a[18:19], v246 offset:5120
    ds_read_b64_tr_b16 a[20:21], v247 offset:4096
    ds_read_b64_tr_b16 a[22:23], v247 offset:5120
    s_waitcnt lgkmcnt(4)
    ds_read_b64_tr_b16 a[24:25], v246 offset:6144
    ds_read_b64_tr_b16 a[26:27], v246 offset:7168
    ds_read_b64_tr_b16 a[28:29], v247 offset:6144
    ds_read_b64_tr_b16 a[30:31], v247 offset:7168
    ds_read_b64_tr_b16 a[32:33], v246 offset:8192
    ds_read_b64_tr_b16 a[34:35], v246 offset:9216
    ds_read_b64_tr_b16 a[36:37], v247 offset:8192
    ds_read_b64_tr_b16 a[38:39], v247 offset:9216
    ds_read_b64_tr_b16 a[40:41], v246 offset:10240
    ds_read_b64_tr_b16 a[42:43], v246 offset:11264
    ds_read_b64_tr_b16 a[44:45], v247 offset:10240
    ds_read_b64_tr_b16 a[46:47], v247 offset:11264
    s_waitcnt lgkmcnt(4)
    ds_read_b64_tr_b16 a[48:49], v246 offset:12288
    ds_read_b64_tr_b16 a[50:51], v246 offset:13312
    ds_read_b64_tr_b16 a[52:53], v247 offset:12288
    ds_read_b64_tr_b16 a[54:55], v247 offset:13312
    ds_read_b64_tr_b16 a[56:57], v246 offset:14336
    ds_read_b64_tr_b16 a[58:59], v246 offset:15360
    ds_read_b64_tr_b16 a[60:61], v247 offset:14336
    ds_read_b64_tr_b16 a[62:63], v247 offset:15360
    ds_read_b64_tr_b16 a[64:65], v246 offset:16384
    ds_read_b64_tr_b16 a[66:67], v246 offset:17408
    ds_read_b64_tr_b16 a[68:69], v247 offset:16384
    ds_read_b64_tr_b16 a[70:71], v247 offset:17408
    s_waitcnt lgkmcnt(4)
    ds_read_b64_tr_b16 a[72:73], v246 offset:18432
    ds_read_b64_tr_b16 a[74:75], v246 offset:19456
    ds_read_b64_tr_b16 a[76:77], v247 offset:18432
    ds_read_b64_tr_b16 a[78:79], v247 offset:19456
    ds_read_b64_tr_b16 a[80:81], v246 offset:20480
    ds_read_b64_tr_b16 a[82:83], v246 offset:21504
    ds_read_b64_tr_b16 a[84:85], v247 offset:20480
    ds_read_b64_tr_b16 a[86:87], v247 offset:21504
    ds_read_b64_tr_b16 a[88:89], v246 offset:22528
    ds_read_b64_tr_b16 a[90:91], v246 offset:23552
    ds_read_b64_tr_b16 a[92:93], v247 offset:22528
    ds_read_b64_tr_b16 a[94:95], v247 offset:23552
    s_waitcnt lgkmcnt(4)
    ds_read_b64_tr_b16 a[96:97], v246 offset:24576
    ds_read_b64_tr_b16 a[98:99], v246 offset:25600
    ds_read_b64_tr_b16 a[100:101], v247 offset:24576
    ds_read_b64_tr_b16 a[102:103], v247 offset:25600
    ds_read_b64_tr_b16 a[104:105], v246 offset:26624
    ds_read_b64_tr_b16 a[106:107], v246 offset:27648
    ds_read_b64_tr_b16 a[108:109], v247 offset:26624
    ds_read_b64_tr_b16 a[110:111], v247 offset:27648
    s_waitcnt lgkmcnt(0)
    s_barrier
    s_lshr_b32 s64, s72, 4
    s_lshl_b32 s64, s64, 14
    s_lshl_b32 s65, s54, 10
    s_add_u32 s64, s64, s65
    s_and_b32 s62, s10, 1
    s_lshl_b32 s65, s62, 9
    s_add_u32 s64, s64, s65
    s_add_u32 s65, s64, 16384
    s_mul_i32 s60, s10, 12288
    v_add_u32 v14, s60, v13
    ds_read_b128 v[128:131], v14 offset:0
    ds_read_b128 v[132:135], v14 offset:1024
    ds_read_b128 v[136:139], v14 offset:2048
    ds_read_b128 v[140:143], v14 offset:3072
    ds_read_b128 v[144:147], v14 offset:4096
    ds_read_b128 v[148:151], v14 offset:5120
    ds_read_b128 v[152:155], v14 offset:6144
    ds_read_b128 v[156:159], v14 offset:7168
    ds_read_b128 v[160:163], v14 offset:8192
    ds_read_b128 v[164:167], v14 offset:9216
    ds_read_b128 v[168:171], v14 offset:10240
    ds_read_b128 v[172:175], v14 offset:11264
    s_waitcnt lgkmcnt(8)
    s_nop 0
    v_pk_add_f32 v[64:65], v[64:65], v[128:129]
    v_pk_add_f32 v[66:67], v[66:67], v[130:131]
    v_pk_add_f32 v[68:69], v[68:69], v[132:133]
    v_pk_add_f32 v[70:71], v[70:71], v[134:135]
    v_pk_add_f32 v[72:73], v[72:73], v[136:137]
    v_pk_add_f32 v[74:75], v[74:75], v[138:139]
    v_pk_add_f32 v[76:77], v[76:77], v[140:141]
    s_add_u32 m0, s59, 0
    s_nop 0
    buffer_load_dwordx4 v240, s[40:43], s76 offen lds
    s_add_u32 s76, s76, 65536
    v_pk_add_f32 v[78:79], v[78:79], v[142:143]
    s_waitcnt lgkmcnt(0)
    s_nop 0
    v_pk_add_f32 v[144:145], v[144:145], v[160:161]
    v_pk_add_f32 v[146:147], v[146:147], v[162:163]
    v_pk_add_f32 v[148:149], v[148:149], v[164:165]
    v_pk_add_f32 v[150:151], v[150:151], v[166:167]
    v_pk_add_f32 v[152:153], v[152:153], v[168:169]
    v_pk_add_f32 v[154:155], v[154:155], v[170:171]
    s_add_u32 m0, s59, 1024
    s_nop 0
    buffer_load_dwordx4 v240, s[40:43], s77 offen lds
    s_nop 0
    s_add_u32 s77, s77, 65536
    v_pk_add_f32 v[156:157], v[156:157], v[172:173]
    v_pk_add_f32 v[158:159], v[158:159], v[174:175]
    v_pk_add_f32 v[128:129], v[64:65], v[144:145]
    v_pk_add_f32 v[130:131], v[66:67], v[146:147]
    v_pk_add_f32 v[132:133], v[68:69], v[148:149]
    v_pk_add_f32 v[134:135], v[70:71], v[150:151]
    v_pk_add_f32 v[136:137], v[72:73], v[152:153]
    v_pk_add_f32 v[138:139], v[74:75], v[154:155]
    s_add_u32 m0, s59, 2048
    s_nop 0
    buffer_load_dwordx4 v240, s[40:43], s76 offen lds
    s_nop 0
    s_add_u32 s76, s76, 65536
    v_pk_add_f32 v[140:141], v[76:77], v[156:157]
    v_pk_add_f32 v[142:143], v[78:79], v[158:159]
    v_cvt_pk_bf16_f32 v144, v128, v129
    v_cvt_pk_bf16_f32 v145, v130, v131
    v_cvt_pk_bf16_f32 v146, v132, v133
    v_cvt_pk_bf16_f32 v147, v134, v135
    v_cvt_pk_bf16_f32 v148, v136, v137
    v_cvt_pk_bf16_f32 v149, v138, v139
    s_add_u32 m0, s59, 3072
    s_nop 0
    buffer_load_dwordx4 v240, s[40:43], s77 offen lds
    s_add_u32 s77, s77, 65536
    v_cvt_pk_bf16_f32 v150, v140, v141
    v_cvt_pk_bf16_f32 v151, v142, v143
    v_lshlrev_b32 v128, 16, v144
    v_and_b32 v129, 0xffff0000, v144
    v_lshlrev_b32_e64 v130, 16, v145
    v_and_b32 v131, 0xffff0000, v145
    v_lshlrev_b32_e64 v132, 16, v146
    v_and_b32 v133, 0xffff0000, v146
    s_add_u32 m0, s59, 4096
    s_nop 0
    buffer_load_dwordx4 v240, s[40:43], s76 offen lds
    s_add_u32 s76, s76, 65536
    v_lshlrev_b32 v134, 16, v147
    v_and_b32 v135, 0xffff0000, v147
    v_lshlrev_b32_e64 v136, 16, v148
    v_and_b32 v137, 0xffff0000, v148
    v_lshlrev_b32_e64 v138, 16, v149
    v_and_b32 v139, 0xffff0000, v149
    v_lshlrev_b32_e64 v140, 16, v150
    v_and_b32 v141, 0xffff0000, v150
    s_add_u32 m0, s59, 5120
    s_nop 0
    buffer_load_dwordx4 v240, s[40:43], s77 offen lds
    s_add_u32 s77, s77, 65536
    v_lshlrev_b32 v142, 16, v151
    v_and_b32 v143, 0xffff0000, v151
    v_pk_add_f32 v[128:129], v[128:129], v[28:29]
    v_pk_add_f32 v[130:131], v[130:131], v[30:31]
    v_pk_add_f32 v[132:133], v[132:133], v[32:33]
    v_pk_add_f32 v[134:135], v[134:135], v[34:35]
    v_pk_add_f32 v[136:137], v[136:137], v[36:37]
    v_pk_add_f32 v[138:139], v[138:139], v[38:39]
    s_add_u32 m0, s59, 6144
    s_nop 0
    buffer_load_dwordx4 v240, s[40:43], s76 offen lds
    s_nop 0
    s_add_u32 s76, s76, 65536
    v_pk_add_f32 v[140:141], v[140:141], v[40:41]
    v_pk_add_f32 v[142:143], v[142:143], v[42:43]
    v_cvt_pk_bf16_f32 v144, v128, v129
    v_cvt_pk_bf16_f32 v145, v130, v131
    v_cvt_pk_bf16_f32 v146, v132, v133
    v_cvt_pk_bf16_f32 v147, v134, v135
    v_cvt_pk_bf16_f32 v148, v136, v137
    v_cvt_pk_bf16_f32 v149, v138, v139
    s_add_u32 m0, s59, 7168
    s_nop 0
    buffer_load_dwordx4 v240, s[40:43], s77 offen lds
    s_add_u32 s77, s77, 65536
    v_cvt_pk_bf16_f32 v150, v140, v141
    v_cvt_pk_bf16_f32 v151, v142, v143
    v_lshlrev_b32 v128, 16, v144
    v_and_b32 v129, 0xffff0000, v144
    v_lshlrev_b32_e64 v130, 16, v145
    v_and_b32 v131, 0xffff0000, v145
    v_lshlrev_b32_e64 v132, 16, v146
    v_and_b32 v133, 0xffff0000, v146
    s_add_u32 m0, s59, 8192
    s_nop 0
    buffer_load_dwordx4 v240, s[40:43], s76 offen lds
    s_add_u32 s76, s76, 65536
    v_lshlrev_b32 v134, 16, v147
    v_and_b32 v135, 0xffff0000, v147
    v_lshlrev_b32_e64 v136, 16, v148
    v_and_b32 v137, 0xffff0000, v148
    v_lshlrev_b32_e64 v138, 16, v149
    v_and_b32 v139, 0xffff0000, v149
    v_lshlrev_b32_e64 v140, 16, v150
    v_and_b32 v141, 0xffff0000, v150
    s_add_u32 m0, s59, 9216
    s_nop 0
    buffer_load_dwordx4 v240, s[40:43], s77 offen lds
    s_add_u32 s77, s77, 65536
    v_lshlrev_b32 v142, 16, v151
    v_and_b32 v143, 0xffff0000, v151
    s_mov_b32 s66, 0x3d372713
    s_mov_b32 s67, 0x3d372713
    s_mov_b32 s68, 0xc0135761
    s_mov_b32 s69, 0xc0135761
    v_pk_mul_f32 v[160:161], v[128:129], v[128:129]
    v_pk_mul_f32 v[162:163], v[130:131], v[130:131]
    s_add_u32 m0, s59, 10240
    s_nop 0
    buffer_load_dwordx4 v240, s[40:43], s76 offen lds
    s_nop 0
    s_add_u32 s76, s76, 65536
    v_pk_mul_f32 v[164:165], v[132:133], v[132:133]
    v_pk_mul_f32 v[166:167], v[134:135], v[134:135]
    v_pk_mul_f32 v[168:169], v[136:137], v[136:137]
    v_pk_mul_f32 v[170:171], v[138:139], v[138:139]
    v_pk_mul_f32 v[172:173], v[140:141], v[140:141]
    v_pk_mul_f32 v[174:175], v[142:143], v[142:143]
    v_pk_mul_f32 v[160:161], v[160:161], s[66:67]
    v_pk_mul_f32 v[162:163], v[162:163], s[66:67]
    s_add_u32 m0, s59, 11264
    s_nop 0
    buffer_load_dwordx4 v240, s[40:43], s77 offen lds
    s_nop 0
    s_add_u32 s77, s77, 65536
    v_pk_mul_f32 v[164:165], v[164:165], s[66:67]
    v_pk_mul_f32 v[166:167], v[166:167], s[66:67]
    v_pk_mul_f32 v[168:169], v[168:169], s[66:67]
    v_pk_mul_f32 v[170:171], v[170:171], s[66:67]
    v_pk_mul_f32 v[172:173], v[172:173], s[66:67]
    v_pk_mul_f32 v[174:175], v[174:175], s[66:67]
    v_pk_fma_f32 v[160:161], v[160:161], v[128:129], v[128:129]
    v_pk_fma_f32 v[162:163], v[162:163], v[130:131], v[130:131]
    s_add_u32 m0, s59, 12288
    s_nop 0
    buffer_load_dwordx4 v240, s[40:43], s76 offen lds
    s_nop 0
    s_add_u32 s76, s76, 65536
    v_pk_fma_f32 v[164:165], v[164:165], v[132:133], v[132:133]
    v_pk_fma_f32 v[166:167], v[166:167], v[134:135], v[134:135]
    v_pk_fma_f32 v[168:169], v[168:169], v[136:137], v[136:137]
    v_pk_fma_f32 v[170:171], v[170:171], v[138:139], v[138:139]
    v_pk_fma_f32 v[172:173], v[172:173], v[140:141], v[140:141]
    v_pk_fma_f32 v[174:175], v[174:175], v[142:143], v[142:143]
    v_pk_mul_f32 v[160:161], v[160:161], s[68:69]
    v_pk_mul_f32 v[162:163], v[162:163], s[68:69]
    s_add_u32 m0, s59, 13312
    s_nop 0
    buffer_load_dwordx4 v240, s[40:43], s77 offen lds
    s_nop 0
    s_add_u32 s77, s77, 65536
    v_pk_mul_f32 v[164:165], v[164:165], s[68:69]
    v_pk_mul_f32 v[166:167], v[166:167], s[68:69]
    v_pk_mul_f32 v[168:169], v[168:169], s[68:69]
    v_pk_mul_f32 v[170:171], v[170:171], s[68:69]
    v_pk_mul_f32 v[172:173], v[172:173], s[68:69]
    v_pk_mul_f32 v[174:175], v[174:175], s[68:69]
    v_exp_f32 v160, v160
    v_exp_f32 v161, v161
    v_exp_f32 v162, v162
    v_exp_f32 v163, v163
    v_exp_f32 v164, v164
    v_exp_f32 v165, v165
    v_exp_f32 v166, v166
    v_exp_f32 v167, v167
    v_exp_f32 v168, v168
    v_exp_f32 v169, v169
    v_exp_f32 v170, v170
    v_exp_f32 v171, v171
    v_exp_f32 v172, v172
    v_exp_f32 v173, v173
    v_exp_f32 v174, v174
    v_exp_f32 v175, v175
    v_add_f32 v160, 1.0, v160
    v_add_f32 v161, 1.0, v161
    v_add_f32 v162, 1.0, v162
    v_add_f32 v163, 1.0, v163
    v_add_f32 v164, 1.0, v164
    v_add_f32 v165, 1.0, v165
    v_add_f32 v166, 1.0, v166
    v_add_f32 v167, 1.0, v167
    v_add_f32 v168, 1.0, v168
    v_add_f32 v169, 1.0, v169
    v_add_f32 v170, 1.0, v170
    v_add_f32 v171, 1.0, v171
    v_add_f32 v172, 1.0, v172
    v_add_f32 v173, 1.0, v173
    v_add_f32 v174, 1.0, v174
    v_add_f32 v175, 1.0, v175
    v_rcp_f32 v160, v160
    v_rcp_f32 v161, v161
    v_rcp_f32 v162, v162
    v_rcp_f32 v163, v163
    v_rcp_f32 v164, v164
    v_rcp_f32 v165, v165
    v_rcp_f32 v166, v166
    v_rcp_f32 v167, v167
    v_rcp_f32 v168, v168
    v_rcp_f32 v169, v169
    v_rcp_f32 v170, v170
    v_rcp_f32 v171, v171
    v_rcp_f32 v172, v172
    v_rcp_f32 v173, v173
    v_rcp_f32 v174, v174
    v_rcp_f32 v175, v175
    v_pk_mul_f32 v[128:129], v[128:129], v[160:161]
    v_pk_mul_f32 v[130:131], v[130:131], v[162:163]
    v_pk_mul_f32 v[132:133], v[132:133], v[164:165]
    v_pk_mul_f32 v[134:135], v[134:135], v[166:167]
    v_pk_mul_f32 v[136:137], v[136:137], v[168:169]
    v_pk_mul_f32 v[138:139], v[138:139], v[170:171]
    v_pk_mul_f32 v[140:141], v[140:141], v[172:173]
    v_pk_mul_f32 v[142:143], v[142:143], v[174:175]
    v_cvt_pk_bf16_f32 v144, v128, v129
    v_cvt_pk_bf16_f32 v145, v130, v131
    v_cvt_pk_bf16_f32 v146, v132, v133
    v_cvt_pk_bf16_f32 v147, v134, v135
    v_cvt_pk_bf16_f32 v148, v136, v137
    v_cvt_pk_bf16_f32 v149, v138, v139
    v_cvt_pk_bf16_f32 v150, v140, v141
    v_cvt_pk_bf16_f32 v151, v142, v143
    buffer_store_dwordx4 v[144:147], v10, s[32:35], s64 offen sc1
    buffer_store_dwordx4 v[148:151], v10, s[32:35], s65 offen sc1
    s_add_u32 m0, s59, 14336
    s_nop 0
    buffer_load_dwordx4 v240, s[40:43], s76 offen lds
    s_add_u32 s76, s76, 65536
    s_add_u32 m0, s59, 15360
    s_nop 0
    buffer_load_dwordx4 v240, s[40:43], s77 offen lds
    s_add_u32 s77, s77, 65536
    s_add_u32 m0, s59, 16384
    s_nop 0
    buffer_load_dwordx4 v240, s[40:43], s76 offen lds
    s_add_u32 s76, s76, 65536
    s_add_u32 m0, s59, 17408
    s_nop 0
    buffer_load_dwordx4 v240, s[40:43], s77 offen lds
    s_add_u32 s77, s77, 65536
    s_add_u32 m0, s59, 18432
    s_nop 0
    buffer_load_dwordx4 v240, s[40:43], s76 offen lds
    s_add_u32 s76, s76, 65536
    s_add_u32 m0, s59, 19456
    s_nop 0
    buffer_load_dwordx4 v240, s[40:43], s77 offen lds
    s_add_u32 s77, s77, 65536
    s_add_u32 m0, s59, 20480
    s_nop 0
    buffer_load_dwordx4 v240, s[40:43], s76 offen lds
    s_add_u32 s76, s76, 65536
    s_add_u32 m0, s59, 21504
    s_nop 0
    buffer_load_dwordx4 v240, s[40:43], s77 offen lds
    s_add_u32 s77, s77, 65536
    s_add_u32 m0, s59, 22528
    s_nop 0
    buffer_load_dwordx4 v240, s[40:43], s76 offen lds
    s_add_u32 s76, s76, 65536
    s_add_u32 m0, s59, 23552
    s_nop 0
    buffer_load_dwordx4 v240, s[40:43], s77 offen lds
    s_add_u32 s77, s77, 65536
    s_add_u32 m0, s59, 24576
    s_nop 0
    buffer_load_dwordx4 v240, s[40:43], s76 offen lds
    s_add_u32 s76, s76, 65536
    s_add_u32 m0, s59, 25600
    s_nop 0
    buffer_load_dwordx4 v240, s[40:43], s77 offen lds
    s_add_u32 s77, s77, 65536
    s_add_u32 m0, s59, 26624
    s_nop 0
    buffer_load_dwordx4 v240, s[40:43], s76 offen lds
    s_add_u32 s76, s76, 65536
    s_add_u32 m0, s59, 27648
    s_nop 0
    buffer_load_dwordx4 v240, s[40:43], s77 offen lds
    s_add_u32 s77, s77, 65536
    s_branch L_stage2
L_skipG1:
    s_waitcnt vmcnt(0) lgkmcnt(0)
    ds_read_b64_tr_b16 a[0:1], v246 offset:0
    ds_read_b64_tr_b16 a[2:3], v246 offset:1024
    ds_read_b64_tr_b16 a[4:5], v247 offset:0
    ds_read_b64_tr_b16 a[6:7], v247 offset:1024
    ds_read_b64_tr_b16 a[8:9], v246 offset:2048
    ds_read_b64_tr_b16 a[10:11], v246 offset:3072
    ds_read_b64_tr_b16 a[12:13], v247 offset:2048
    ds_read_b64_tr_b16 a[14:15], v247 offset:3072
    ds_read_b64_tr_b16 a[16:17], v246 offset:4096
    ds_read_b64_tr_b16 a[18:19], v246 offset:5120
    ds_read_b64_tr_b16 a[20:21], v247 offset:4096
    ds_read_b64_tr_b16 a[22:23], v247 offset:5120
    s_waitcnt lgkmcnt(4)
    ds_read_b64_tr_b16 a[24:25], v246 offset:6144
    ds_read_b64_tr_b16 a[26:27], v246 offset:7168
    ds_read_b64_tr_b16 a[28:29], v247 offset:6144
    ds_read_b64_tr_b16 a[30:31], v247 offset:7168
    ds_read_b64_tr_b16 a[32:33], v246 offset:8192
    ds_read_b64_tr_b16 a[34:35], v246 offset:9216
    ds_read_b64_tr_b16 a[36:37], v247 offset:8192
    ds_read_b64_tr_b16 a[38:39], v247 offset:9216
    ds_read_b64_tr_b16 a[40:41], v246 offset:10240
    ds_read_b64_tr_b16 a[42:43], v246 offset:11264
    ds_read_b64_tr_b16 a[44:45], v247 offset:10240
    ds_read_b64_tr_b16 a[46:47], v247 offset:11264
    s_waitcnt lgkmcnt(4)
    ds_read_b64_tr_b16 a[48:49], v246 offset:12288
    ds_read_b64_tr_b16 a[50:51], v246 offset:13312
    ds_read_b64_tr_b16 a[52:53], v247 offset:12288
    ds_read_b64_tr_b16 a[54:55], v247 offset:13312
    ds_read_b64_tr_b16 a[56:57], v246 offset:14336
    ds_read_b64_tr_b16 a[58:59], v246 offset:15360
    ds_read_b64_tr_b16 a[60:61], v247 offset:14336
    ds_read_b64_tr_b16 a[62:63], v247 offset:15360
    ds_read_b64_tr_b16 a[64:65], v246 offset:16384
    ds_read_b64_tr_b16 a[66:67], v246 offset:17408
    ds_read_b64_tr_b16 a[68:69], v247 offset:16384
    ds_read_b64_tr_b16 a[70:71], v247 offset:17408
    s_waitcnt lgkmcnt(4)
    ds_read_b64_tr_b16 a[72:73], v246 offset:18432
    ds_read_b64_tr_b16 a[74:75], v246 offset:19456
    ds_read_b64_tr_b16 a[76:77], v247 offset:18432
    ds_read_b64_tr_b16 a[78:79], v247 offset:19456
    ds_read_b64_tr_b16 a[80:81], v246 offset:20480
    ds_read_b64_tr_b16 a[82:83], v246 offset:21504
    ds_read_b64_tr_b16 a[84:85], v247 offset:20480
    ds_read_b64_tr_b16 a[86:87], v247 offset:21504
    ds_read_b64_tr_b16 a[88:89], v246 offset:22528
    ds_read_b64_tr_b16 a[90:91], v246 offset:23552
    ds_read_b64_tr_b16 a[92:93], v247 offset:22528
    ds_read_b64_tr_b16 a[94:95], v247 offset:23552
    s_waitcnt lgkmcnt(4)
    ds_read_b64_tr_b16 a[96:97], v246 offset:24576
    ds_read_b64_tr_b16 a[98:99], v246 offset:25600
    ds_read_b64_tr_b16 a[100:101], v247 offset:24576
    ds_read_b64_tr_b16 a[102:103], v247 offset:25600
    ds_read_b64_tr_b16 a[104:105], v246 offset:26624
    ds_read_b64_tr_b16 a[106:107], v246 offset:27648
    ds_read_b64_tr_b16 a[108:109], v247 offset:26624
    ds_read_b64_tr_b16 a[110:111], v247 offset:27648
    s_waitcnt lgkmcnt(0)
    s_add_u32 m0, s59, 0
    s_nop 0
    buffer_load_dwordx4 v240, s[40:43], s76 offen lds
    s_add_u32 s76, s76, 65536
    s_add_u32 m0, s59, 1024
    s_nop 0
    buffer_load_dwordx4 v240, s[40:43], s77 offen lds
    s_add_u32 s77, s77, 65536
    s_add_u32 m0, s59, 2048
    s_nop 0
    buffer_load_dwordx4 v240, s[40:43], s76 offen lds
    s_add_u32 s76, s76, 65536
    s_add_u32 m0, s59, 3072
    s_nop 0
    buffer_load_dwordx4 v240, s[40:43], s77 offen lds
    s_add_u32 s77, s77, 65536
    s_add_u32 m0, s59, 4096
    s_nop 0
    buffer_load_dwordx4 v240, s[40:43], s76 offen lds
    s_add_u32 s76, s76, 65536
    s_add_u32 m0, s59, 5120
    s_nop 0
    buffer_load_dwordx4 v240, s[40:43], s77 offen lds
    s_add_u32 s77, s77, 65536
    s_add_u32 m0, s59, 6144
    s_nop 0
    buffer_load_dwordx4 v240, s[40:43], s76 offen lds
    s_add_u32 s76, s76, 65536
    s_add_u32 m0, s59, 7168
    s_nop 0
    buffer_load_dwordx4 v240, s[40:43], s77 offen lds
    s_add_u32 s77, s77, 65536
    s_add_u32 m0, s59, 8192
    s_nop 0
    buffer_load_dwordx4 v240, s[40:43], s76 offen lds
    s_add_u32 s76, s76, 65536
    s_add_u32 m0, s59, 9216
    s_nop 0
    buffer_load_dwordx4 v240, s[40:43], s77 offen lds
    s_add_u32 s77, s77, 65536
    s_add_u32 m0, s59, 10240
    s_nop 0
    buffer_load_dwordx4 v240, s[40:43], s76 offen lds
    s_add_u32 s76, s76, 65536
    s_add_u32 m0, s59, 11264
    s_nop 0
    buffer_load_dwordx4 v240, s[40:43], s77 offen lds
    s_add_u32 s77, s77, 65536
    s_add_u32 m0, s59, 12288
    s_nop 0
    buffer_load_dwordx4 v240, s[40:43], s76 offen lds
    s_add_u32 s76, s76, 65536
    s_add_u32 m0, s59, 13312
    s_nop 0
    buffer_load_dwordx4 v240, s[40:43], s77 offen lds
    s_add_u32 s77, s77, 65536
    s_add_u32 m0, s59, 14336
    s_nop 0
    buffer_load_dwordx4 v240, s[40:43], s76 offen lds
    s_add_u32 s76, s76, 65536
    s_add_u32 m0, s59, 15360
    s_nop 0
    buffer_load_dwordx4 v240, s[40:43], s77 offen lds
    s_add_u32 s77, s77, 65536
    s_add_u32 m0, s59, 16384
    s_nop 0
    buffer_load_dwordx4 v240, s[40:43], s76 offen lds
    s_add_u32 s76, s76, 65536
    s_add_u32 m0, s59, 17408
    s_nop 0
    buffer_load_dwordx4 v240, s[40:43], s77 offen lds
    s_add_u32 s77, s77, 65536
    s_add_u32 m0, s59, 18432
    s_nop 0
    buffer_load_dwordx4 v240, s[40:43], s76 offen lds
    s_add_u32 s76, s76, 65536
    s_add_u32 m0, s59, 19456
    s_nop 0
    buffer_load_dwordx4 v240, s[40:43], s77 offen lds
    s_add_u32 s77, s77, 65536
    s_add_u32 m0, s59, 20480
    s_nop 0
    buffer_load_dwordx4 v240, s[40:43], s76 offen lds
    s_add_u32 s76, s76, 65536
    s_add_u32 m0, s59, 21504
    s_nop 0
    buffer_load_dwordx4 v240, s[40:43], s77 offen lds
    s_add_u32 s77, s77, 65536
    s_add_u32 m0, s59, 22528
    s_nop 0
    buffer_load_dwordx4 v240, s[40:43], s76 offen lds
    s_add_u32 s76, s76, 65536
    s_add_u32 m0, s59, 23552
    s_nop 0
    buffer_load_dwordx4 v240, s[40:43], s77 offen lds
    s_add_u32 s77, s77, 65536
    s_add_u32 m0, s59, 24576
    s_nop 0
    buffer_load_dwordx4 v240, s[40:43], s76 offen lds
    s_add_u32 s76, s76, 65536
    s_add_u32 m0, s59, 25600
    s_nop 0
    buffer_load_dwordx4 v240, s[40:43], s77 offen lds
    s_add_u32 s77, s77, 65536
    s_add_u32 m0, s59, 26624
    s_nop 0
    buffer_load_dwordx4 v240, s[40:43], s76 offen lds
    s_add_u32 s76, s76, 65536
    s_add_u32 m0, s59, 27648
    s_nop 0
    buffer_load_dwordx4 v240, s[40:43], s77 offen lds
    s_add_u32 s77, s77, 65536
L_stage2:
    s_mul_i32 s71, s10, 458752
    s_lshl_b32 s60, s56, 10
    s_add_u32 s71, s71, s60
    v_min_u32 v15, 55, v2
    v_lshlrev_b32 v15, 13, v15
    v_add_u32 v15, 1020, v15
    s_waitcnt vmcnt(0)
    buffer_load_dword v14, v15, s[32:35], s71 offen sc1
    ds_read_b64_tr_b16 a[112:113], v246 offset:0
    ds_read_b64_tr_b16 a[114:115], v246 offset:1024
    ds_read_b64_tr_b16 a[116:117], v247 offset:0
    ds_read_b64_tr_b16 a[118:119], v247 offset:1024
    ds_read_b64_tr_b16 a[120:121], v246 offset:2048
    ds_read_b64_tr_b16 a[122:123], v246 offset:3072
    ds_read_b64_tr_b16 a[124:125], v247 offset:2048
    ds_read_b64_tr_b16 a[126:127], v247 offset:3072
    ds_read_b64_tr_b16 a[128:129], v246 offset:4096
    ds_read_b64_tr_b16 a[130:131], v246 offset:5120
    ds_read_b64_tr_b16 a[132:133], v247 offset:4096
    ds_read_b64_tr_b16 a[134:135], v247 offset:5120
    s_waitcnt lgkmcnt(4)
    ds_read_b64_tr_b16 a[136:137], v246 offset:6144
    ds_read_b64_tr_b16 a[138:139], v246 offset:7168
    ds_read_b64_tr_b16 a[140:141], v247 offset:6144
    ds_read_b64_tr_b16 a[142:143], v247 offset:7168
    ds_read_b64_tr_b16 a[144:145], v246 offset:8192
    ds_read_b64_tr_b16 a[146:147], v246 offset:9216
    ds_read_b64_tr_b16 a[148:149], v247 offset:8192
    ds_read_b64_tr_b16 a[150:151], v247 offset:9216
    ds_read_b64_tr_b16 a[152:153], v246 offset:10240
    ds_read_b64_tr_b16 a[154:155], v246 offset:11264
    ds_read_b64_tr_b16 a[156:157], v247 offset:10240
    ds_read_b64_tr_b16 a[158:159], v247 offset:11264
    s_waitcnt lgkmcnt(4)
    ds_read_b64_tr_b16 a[160:161], v246 offset:12288
    ds_read_b64_tr_b16 a[162:163], v246 offset:13312
    ds_read_b64_tr_b16 a[164:165], v247 offset:12288
    ds_read_b64_tr_b16 a[166:167], v247 offset:13312
    ds_read_b64_tr_b16 a[168:169], v246 offset:14336
    ds_read_b64_tr_b16 a[170:171], v246 offset:15360
    ds_read_b64_tr_b16 a[172:173], v247 offset:14336
    ds_read_b64_tr_b16 a[174:175], v247 offset:15360
    ds_read_b64_tr_b16 a[176:177], v246 offset:16384
    ds_read_b64_tr_b16 a[178:179], v246 offset:17408
    ds_read_b64_tr_b16 a[180:181], v247 offset:16384
    ds_read_b64_tr_b16 a[182:183], v247 offset:17408
    s_waitcnt lgkmcnt(4)
    ds_read_b64_tr_b16 a[184:185], v246 offset:18432
    ds_read_b64_tr_b16 a[186:187], v246 offset:19456
    ds_read_b64_tr_b16 a[188:189], v247 offset:18432
    ds_read_b64_tr_b16 a[190:191], v247 offset:19456
    ds_read_b64_tr_b16 a[192:193], v246 offset:20480
    ds_read_b64_tr_b16 a[194:195], v246 offset:21504
    ds_read_b64_tr_b16 a[196:197], v247 offset:20480
    ds_read_b64_tr_b16 a[198:199], v247 offset:21504
    ds_read_b64_tr_b16 a[200:201], v246 offset:22528
    ds_read_b64_tr_b16 a[202:203], v246 offset:23552
    ds_read_b64_tr_b16 a[204:205], v247 offset:22528
    ds_read_b64_tr_b16 a[206:207], v247 offset:23552
    s_waitcnt lgkmcnt(4)
    ds_read_b64_tr_b16 a[208:209], v246 offset:24576
    ds_read_b64_tr_b16 a[210:211], v246 offset:25600
    ds_read_b64_tr_b16 a[212:213], v247 offset:24576
    ds_read_b64_tr_b16 a[214:215], v247 offset:25600
    ds_read_b64_tr_b16 a[216:217], v246 offset:26624
    ds_read_b64_tr_b16 a[218:219], v246 offset:27648
    ds_read_b64_tr_b16 a[220:221], v247 offset:26624
    ds_read_b64_tr_b16 a[222:223], v247 offset:27648
    s_mov_b32 s61, 0
    s_waitcnt vmcnt(0)
    v_cmp_eq_u32 vcc, -1, v14
    s_nop 4
    s_cbranch_vccz L_pr96_ok
L_pr96:
    buffer_load_dword v14, v15, s[32:35], s71 offen sc1
    s_add_u32 s61, s61, 1
    s_waitcnt vmcnt(0)
    v_cmp_eq_u32 vcc, -1, v14
    s_nop 4
    s_cbranch_vccz L_pr96_ok
    s_cmp_lt_u32 s61, 131072
    s_cbranch_scc1 L_pr96
L_pr96_ok:
    s_lshr_b32 s61, s10, 1
    s_lshl_b32 s63, s57, 6
    s_lshl_b32 s64, s61, 5
    s_add_u32 s64, s64, s63
    v_add_u32 v15, s64, v7
    v_lshlrev_b32 v17, 1, v15
    global_load_ushort v18, v17, s[50:51]
    v_lshrrev_b32 v15, 3, v0
    v_add_u32 v15, s63, v15
    v_lshlrev_b32 v16, 10, v15
    v_and_b32 v15, 7, v0
    v_lshl_add_u32 v16, v15, 4, v16
    s_lshl_b32 s70, s56, 7
    s_add_u32 s74, s70, 32768
    buffer_load_dwordx4 v[20:23], v16, s[24:27], s70 offen sc1
    buffer_load_dwordx4 v[24:27], v16, s[24:27], s74 offen sc1
    s_waitcnt lgkmcnt(0)
    s_barrier
    s_mov_b32 s73, s71
    buffer_load_dwordx4 v[128:131], v8, s[32:35], s73 offen sc1
    buffer_load_dwordx4 v[132:135], v9, s[32:35], s73 offen sc1
    s_add_u32 s73, s73, 16384
    buffer_load_dwordx4 v[136:139], v8, s[32:35], s73 offen sc1
    buffer_load_dwordx4 v[140:143], v9, s[32:35], s73 offen sc1
    s_add_u32 s73, s73, 16384
    buffer_load_dwordx4 v[144:147], v8, s[32:35], s73 offen sc1
    buffer_load_dwordx4 v[148:151], v9, s[32:35], s73 offen sc1
    s_add_u32 s73, s73, 16384
    buffer_load_dwordx4 v[152:155], v8, s[32:35], s73 offen sc1
    buffer_load_dwordx4 v[156:159], v9, s[32:35], s73 offen sc1
    s_add_u32 s73, s73, 16384
    buffer_load_dwordx4 v[160:163], v8, s[32:35], s73 offen sc1
    buffer_load_dwordx4 v[164:167], v9, s[32:35], s73 offen sc1
    s_add_u32 s73, s73, 16384
    s_waitcnt vmcnt(8)
    v_max3_u32 v12, v128, v129, v130
    v_max3_u32 v12, v12, v131, v132
    v_max3_u32 v12, v12, v133, v134
    v_max_u32 v12, v12, v135
    v_cmp_eq_u32 vcc, -1, v12
    s_nop 4
    s_cbranch_vccnz L_rt97
L_rb98:
    v_mfma_f32_32x32x16_bf16 v[64:79], v[128:131], a[0:3], 0
    buffer_load_dwordx4 v[168:171], v8, s[32:35], s73 offen sc1
    v_mfma_f32_32x32x16_bf16 v[80:95], v[132:135], a[0:3], 0
    buffer_load_dwordx4 v[172:175], v9, s[32:35], s73 offen sc1
    s_add_u32 s73, s73, 16384
    s_waitcnt vmcnt(8)
    v_max3_u32 v12, v136, v137, v138
    v_max3_u32 v12, v12, v139, v140
    v_max3_u32 v12, v12, v141, v142
    v_max_u32 v12, v12, v143
    v_cmp_eq_u32 vcc, -1, v12
    v_mfma_f32_32x32x16_bf16 v[96:111], v[128:131], a[4:7], 0
    v_mfma_f32_32x32x16_bf16 v[112:127], v[132:135], a[4:7], 0
    s_nop 2
    s_cbranch_vccnz L_rt99
L_rb100:
    v_mfma_f32_32x32x16_bf16 v[64:79], v[136:139], a[8:11], v[64:79]
    buffer_load_dwordx4 v[176:179], v8, s[32:35], s73 offen sc1
    v_mfma_f32_32x32x16_bf16 v[80:95], v[140:143], a[8:11], v[80:95]
    buffer_load_dwordx4 v[180:183], v9, s[32:35], s73 offen sc1
    s_add_u32 s73, s73, 16384
    s_waitcnt vmcnt(8)
    v_max3_u32 v12, v144, v145, v146
    v_max3_u32 v12, v12, v147, v148
    v_max3_u32 v12, v12, v149, v150
    v_max_u32 v12, v12, v151
    v_cmp_eq_u32 vcc, -1, v12
    v_mfma_f32_32x32x16_bf16 v[96:111], v[136:139], a[12:15], v[96:111]
    v_mfma_f32_32x32x16_bf16 v[112:127], v[140:143], a[12:15], v[112:127]
    s_nop 2
    s_cbranch_vccnz L_rt101
L_rb102:
    v_mfma_f32_32x32x16_bf16 v[64:79], v[144:147], a[16:19], v[64:79]
    buffer_load_dwordx4 v[184:187], v8, s[32:35], s73 offen sc1
    v_mfma_f32_32x32x16_bf16 v[80:95], v[148:151], a[16:19], v[80:95]
    buffer_load_dwordx4 v[188:191], v9, s[32:35], s73 offen sc1
    s_add_u32 s73, s73, 16384
    s_waitcnt vmcnt(8)
    v_max3_u32 v12, v152, v153, v154
    v_max3_u32 v12, v12, v155, v156
    v_max3_u32 v12, v12, v157, v158
    v_max_u32 v12, v12, v159
    v_cmp_eq_u32 vcc, -1, v12
    v_mfma_f32_32x32x16_bf16 v[96:111], v[144:147], a[20:23], v[96:111]
    v_mfma_f32_32x32x16_bf16 v[112:127], v[148:151], a[20:23], v[112:127]
    v_lshlrev_b32 v18, 16, v18
    v_mov_b32 v19, v18
    v_lshlrev_b32_e64 v28, 16, v20
    v_and_b32 v29, 0xffff0000, v20
    s_nop 2
    s_cbranch_vccnz L_rt103
L_rb104:
    v_mfma_f32_32x32x16_bf16 v[64:79], v[152:155], a[24:27], v[64:79]
    buffer_load_dwordx4 v[192:195], v8, s[32:35], s73 offen sc1
    v_mfma_f32_32x32x16_bf16 v[80:95], v[156:159], a[24:27], v[80:95]
    buffer_load_dwordx4 v[196:199], v9, s[32:35], s73 offen sc1
    s_add_u32 s73, s73, 16384
    s_waitcnt vmcnt(8)
    v_max3_u32 v12, v160, v161, v162
    v_max3_u32 v12, v12, v163, v164
    v_max3_u32 v12, v12, v165, v166
    v_max_u32 v12, v12, v167
    v_cmp_eq_u32 vcc, -1, v12
    v_mfma_f32_32x32x16_bf16 v[96:111], v[152:155], a[28:31], v[96:111]
    v_mfma_f32_32x32x16_bf16 v[112:127], v[156:159], a[28:31], v[112:127]
    v_lshlrev_b32 v30, 16, v21
    v_and_b32 v31, 0xffff0000, v21
    v_lshlrev_b32_e64 v32, 16, v22
    v_and_b32 v33, 0xffff0000, v22
    s_nop 2
    s_cbranch_vccnz L_rt105
L_rb106:
    v_mfma_f32_32x32x16_bf16 v[64:79], v[160:163], a[32:35], v[64:79]
    buffer_load_dwordx4 v[200:203], v8, s[32:35], s73 offen sc1
    v_mfma_f32_32x32x16_bf16 v[80:95], v[164:167], a[32:35], v[80:95]
    buffer_load_dwordx4 v[204:207], v9, s[32:35], s73 offen sc1
    s_add_u32 s73, s73, 16384
    s_waitcnt vmcnt(8)
    v_max3_u32 v12, v168, v169, v170
    v_max3_u32 v12, v12, v171, v172
    v_max3_u32 v12, v12, v173, v174
    v_max_u32 v12, v12, v175
    v_cmp_eq_u32 vcc, -1, v12
    v_mfma_f32_32x32x16_bf16 v[96:111], v[160:163], a[36:39], v[96:111]
    v_mfma_f32_32x32x16_bf16 v[112:127], v[164:167], a[36:39], v[112:127]
    v_lshlrev_b32 v34, 16, v23
    v_and_b32 v35, 0xffff0000, v23
    v_lshlrev_b32_e64 v36, 16, v24
    v_and_b32 v37, 0xffff0000, v24
    s_nop 2
    s_cbranch_vccnz L_rt107
L_rb108:
    v_mfma_f32_32x32x16_bf16 v[64:79], v[168:171], a[40:43], v[64:79]
    buffer_load_dwordx4 v[208:211], v8, s[32:35], s73 offen sc1
    v_mfma_f32_32x32x16_bf16 v[80:95], v[172:175], a[40:43], v[80:95]
    buffer_load_dwordx4 v[212:215], v9, s[32:35], s73 offen sc1
    s_add_u32 s73, s73, 16384
    s_waitcnt vmcnt(8)
    v_max3_u32 v12, v176, v177, v178
    v_max3_u32 v12, v12, v179, v180
    v_max3_u32 v12, v12, v181, v182
    v_max_u32 v12, v12, v183
    v_cmp_eq_u32 vcc, -1, v12
    v_mfma_f32_32x32x16_bf16 v[96:111], v[168:171], a[44:47], v[96:111]
    v_mfma_f32_32x32x16_bf16 v[112:127], v[172:175], a[44:47], v[112:127]
    v_lshlrev_b32 v38, 16, v25
    v_and_b32 v39, 0xffff0000, v25
    v_lshlrev_b32_e64 v40, 16, v26
    v_and_b32 v41, 0xffff0000, v26
    s_nop 2
    s_cbranch_vccnz L_rt109
L_rb110:
    v_mfma_f32_32x32x16_bf16 v[64:79], v[176:179], a[48:51], v[64:79]
    buffer_load_dwordx4 v[216:219], v8, s[32:35], s73 offen sc1
    v_mfma_f32_32x32x16_bf16 v[80:95], v[180:183], a[48:51], v[80:95]
    buffer_load_dwordx4 v[220:223], v9, s[32:35], s73 offen sc1
    s_add_u32 s73, s73, 16384
    s_waitcnt vmcnt(8)
    v_max3_u32 v12, v184, v185, v186
    v_max3_u32 v12, v12, v187, v188
    v_max3_u32 v12, v12, v189, v190
    v_max_u32 v12, v12, v191
    v_cmp_eq_u32 vcc, -1, v12
    v_mfma_f32_32x32x16_bf16 v[96:111], v[176:179], a[52:55], v[96:111]
    v_mfma_f32_32x32x16_bf16 v[112:127], v[180:183], a[52:55], v[112:127]
    v_lshlrev_b32 v42, 16, v27
    v_and_b32 v43, 0xffff0000, v27
    s_lshr_b32 s75, s10, 1
    s_lshl_b32 s75, s75, 5
    s_nop 2
    s_cbranch_vccnz L_rt111
L_rb112:
    v_mfma_f32_32x32x16_bf16 v[64:79], v[184:187], a[56:59], v[64:79]
    buffer_load_dwordx4 v[224:227], v8, s[32:35], s73 offen sc1
    v_mfma_f32_32x32x16_bf16 v[80:95], v[188:191], a[56:59], v[80:95]
    buffer_load_dwordx4 v[228:231], v9, s[32:35], s73 offen sc1
    s_add_u32 s73, s73, 16384
    s_waitcnt vmcnt(8)
    v_max3_u32 v12, v192, v193, v194
    v_max3_u32 v12, v12, v195, v196
    v_max3_u32 v12, v12, v197, v198
    v_max_u32 v12, v12, v199
    v_cmp_eq_u32 vcc, -1, v12
    v_mfma_f32_32x32x16_bf16 v[96:111], v[184:187], a[60:63], v[96:111]
    v_mfma_f32_32x32x16_bf16 v[112:127], v[188:191], a[60:63], v[112:127]
    v_add_u32 v44, s75, v7
    v_mul_u32_u24 v44, 144, v44
    v_lshl_add_u32 v44, v6, 6, v44
    s_and_b32 s75, s10, 1
    s_nop 2
    s_cbranch_vccnz L_rt113
L_rb114:
    v_mfma_f32_32x32x16_bf16 v[64:79], v[192:195], a[64:67], v[64:79]
    buffer_load_dwordx4 v[232:235], v8, s[32:35], s73 offen sc1
    v_mfma_f32_32x32x16_bf16 v[80:95], v[196:199], a[64:67], v[80:95]
    buffer_load_dwordx4 v[236:239], v9, s[32:35], s73 offen sc1
    s_add_u32 s73, s73, 16384
    s_waitcnt vmcnt(8)
    v_max3_u32 v12, v200, v201, v202
    v_max3_u32 v12, v12, v203, v204
    v_max3_u32 v12, v12, v205, v206
    v_max_u32 v12, v12, v207
    v_cmp_eq_u32 vcc, -1, v12
    v_mfma_f32_32x32x16_bf16 v[96:111], v[192:195], a[68:71], v[96:111]
    v_mfma_f32_32x32x16_bf16 v[112:127], v[196:199], a[68:71], v[112:127]
    s_lshl_b32 s75, s75, 3
    s_add_u32 s75, s75, 131072
    v_add_u32 v44, s75, v44
    v_lshrrev_b32 v45, 3, v0
    s_nop 2
    s_cbranch_vccnz L_rt115
L_rb116:
    v_mfma_f32_32x32x16_bf16 v[64:79], v[200:203], a[72:75], v[64:79]
    buffer_load_dwordx4 v[128:131], v8, s[32:35], s73 offen sc1
    v_mfma_f32_32x32x16_bf16 v[80:95], v[204:207], a[72:75], v[80:95]
    buffer_load_dwordx4 v[132:135], v9, s[32:35], s73 offen sc1
    s_add_u32 s73, s73, 16384
    s_waitcnt vmcnt(8)
    v_max3_u32 v12, v208, v209, v210
    v_max3_u32 v12, v12, v211, v212
    v_max3_u32 v12, v12, v213, v214
    v_max_u32 v12, v12, v215
    v_cmp_eq_u32 vcc, -1, v12
    v_mfma_f32_32x32x16_bf16 v[96:111], v[200:203], a[76:79], v[96:111]
    v_mfma_f32_32x32x16_bf16 v[112:127], v[204:207], a[76:79], v[112:127]
    v_mul_u32_u24 v45, 144, v45
    v_and_b32_e64 v46, 7, v0
    v_lshl_add_u32 v45, v46, 4, v45
    v_add_u32 v45, 131072, v45
    s_nop 2
    s_cbranch_vccnz L_rt117
L_rb118:
    v_mfma_f32_32x32x16_bf16 v[64:79], v[208:211], a[80:83], v[64:79]
    buffer_load_dwordx4 v[136:139], v8, s[32:35], s73 offen sc1
    v_mfma_f32_32x32x16_bf16 v[80:95], v[212:215], a[80:83], v[80:95]
    buffer_load_dwordx4 v[140:143], v9, s[32:35], s73 offen sc1
    s_add_u32 s73, s73, 16384
    s_waitcnt vmcnt(8)
    v_max3_u32 v12, v216, v217, v218
    v_max3_u32 v12, v12, v219, v220
    v_max3_u32 v12, v12, v221, v222
    v_max_u32 v12, v12, v223
    v_cmp_eq_u32 vcc, -1, v12
    v_mfma_f32_32x32x16_bf16 v[96:111], v[208:211], a[84:87], v[96:111]
    v_mfma_f32_32x32x16_bf16 v[112:127], v[212:215], a[84:87], v[112:127]
    s_nop 2
    s_cbranch_vccnz L_rt119
L_rb120:
    v_mfma_f32_32x32x16_bf16 v[64:79], v[216:219], a[88:91], v[64:79]
    buffer_load_dwordx4 v[144:147], v8, s[32:35], s73 offen sc1
    v_mfma_f32_32x32x16_bf16 v[80:95], v[220:223], a[88:91], v[80:95]
    buffer_load_dwordx4 v[148:151], v9, s[32:35], s73 offen sc1
    s_add_u32 s73, s73, 16384
    s_waitcnt vmcnt(8)
    v_max3_u32 v12, v224, v225, v226
    v_max3_u32 v12, v12, v227, v228
    v_max3_u32 v12, v12, v229, v230
    v_max_u32 v12, v12, v231
    v_cmp_eq_u32 vcc, -1, v12
    v_mfma_f32_32x32x16_bf16 v[96:111], v[216:219], a[92:95], v[96:111]
    v_mfma_f32_32x32x16_bf16 v[112:127], v[220:223], a[92:95], v[112:127]
    s_nop 2
    s_cbranch_vccnz L_rt121
L_rb122:
    v_mfma_f32_32x32x16_bf16 v[64:79], v[224:227], a[96:99], v[64:79]
    buffer_load_dwordx4 v[152:155], v8, s[32:35], s73 offen sc1
    v_mfma_f32_32x32x16_bf16 v[80:95], v[228:231], a[96:99], v[80:95]
    buffer_load_dwordx4 v[156:159], v9, s[32:35], s73 offen sc1
    s_add_u32 s73, s73, 16384
    s_waitcnt vmcnt(8)
    v_max3_u32 v12, v232, v233, v234
    v_max3_u32 v12, v12, v235, v236
    v_max3_u32 v12, v12, v237, v238
    v_max_u32 v12, v12, v239
    v_cmp_eq_u32 vcc, -1, v12
    v_mfma_f32_32x32x16_bf16 v[96:111], v[224:227], a[100:103], v[96:111]
    v_mfma_f32_32x32x16_bf16 v[112:127], v[228:231], a[100:103], v[112:127]
    s_nop 2
    s_cbranch_vccnz L_rt123
L_rb124:
    v_mfma_f32_32x32x16_bf16 v[64:79], v[232:235], a[104:107], v[64:79]
    buffer_load_dwordx4 v[160:163], v8, s[32:35], s73 offen sc1
    v_mfma_f32_32x32x16_bf16 v[80:95], v[236:239], a[104:107], v[80:95]
    buffer_load_dwordx4 v[164:167], v9, s[32:35], s73 offen sc1
    s_add_u32 s73, s73, 16384
    s_waitcnt vmcnt(8)
    v_max3_u32 v12, v128, v129, v130
    v_max3_u32 v12, v12, v131, v132
    v_max3_u32 v12, v12, v133, v134
    v_max_u32 v12, v12, v135
    v_cmp_eq_u32 vcc, -1, v12
    v_mfma_f32_32x32x16_bf16 v[96:111], v[232:235], a[108:111], v[96:111]
    v_mfma_f32_32x32x16_bf16 v[112:127], v[236:239], a[108:111], v[112:127]
    s_nop 2
    s_cbranch_vccnz L_rt125
L_rb126:
    v_mfma_f32_32x32x16_bf16 v[64:79], v[128:131], a[112:115], v[64:79]
    buffer_load_dwordx4 v[168:171], v8, s[32:35], s73 offen sc1
    v_mfma_f32_32x32x16_bf16 v[80:95], v[132:135], a[112:115], v[80:95]
    buffer_load_dwordx4 v[172:175], v9, s[32:35], s73 offen sc1
    s_add_u32 s73, s73, 16384
    s_waitcnt vmcnt(8)
    v_max3_u32 v12, v136, v137, v138
    v_max3_u32 v12, v12, v139, v140
    v_max3_u32 v12, v12, v141, v142
    v_max_u32 v12, v12, v143
    v_cmp_eq_u32 vcc, -1, v12
    v_mfma_f32_32x32x16_bf16 v[96:111], v[128:131], a[116:119], v[96:111]
    v_mfma_f32_32x32x16_bf16 v[112:127], v[132:135], a[116:119], v[112:127]
    s_nop 2
    s_cbranch_vccnz L_rt127
L_rb128:
    v_mfma_f32_32x32x16_bf16 v[64:79], v[136:139], a[120:123], v[64:79]
    buffer_load_dwordx4 v[176:179], v8, s[32:35], s73 offen sc1
    v_mfma_f32_32x32x16_bf16 v[80:95], v[140:143], a[120:123], v[80:95]
    buffer_load_dwordx4 v[180:183], v9, s[32:35], s73 offen sc1
    s_add_u32 s73, s73, 16384
    s_waitcnt vmcnt(8)
    v_max3_u32 v12, v144, v145, v146
    v_max3_u32 v12, v12, v147, v148
    v_max3_u32 v12, v12, v149, v150
    v_max_u32 v12, v12, v151
    v_cmp_eq_u32 vcc, -1, v12
    v_mfma_f32_32x32x16_bf16 v[96:111], v[136:139], a[124:127], v[96:111]
    v_mfma_f32_32x32x16_bf16 v[112:127], v[140:143], a[124:127], v[112:127]
    s_nop 2
    s_cbranch_vccnz L_rt129
L_rb130:
    v_mfma_f32_32x32x16_bf16 v[64:79], v[144:147], a[128:131], v[64:79]
    buffer_load_dwordx4 v[184:187], v8, s[32:35], s73 offen sc1
    v_mfma_f32_32x32x16_bf16 v[80:95], v[148:151], a[128:131], v[80:95]
    buffer_load_dwordx4 v[188:191], v9, s[32:35], s73 offen sc1
    s_add_u32 s73, s73, 16384
    s_waitcnt vmcnt(8)
    v_max3_u32 v12, v152, v153, v154
    v_max3_u32 v12, v12, v155, v156
    v_max3_u32 v12, v12, v157, v158
    v_max_u32 v12, v12, v159
    v_cmp_eq_u32 vcc, -1, v12
    v_mfma_f32_32x32x16_bf16 v[96:111], v[144:147], a[132:135], v[96:111]
    v_mfma_f32_32x32x16_bf16 v[112:127], v[148:151], a[132:135], v[112:127]
    s_nop 2
    s_cbranch_vccnz L_rt131
L_rb132:
    v_mfma_f32_32x32x16_bf16 v[64:79], v[152:155], a[136:139], v[64:79]
    buffer_load_dwordx4 v[192:195], v8, s[32:35], s73 offen sc1
    v_mfma_f32_32x32x16_bf16 v[80:95], v[156:159], a[136:139], v[80:95]
    buffer_load_dwordx4 v[196:199], v9, s[32:35], s73 offen sc1
    s_add_u32 s73, s73, 16384
    s_waitcnt vmcnt(8)
    v_max3_u32 v12, v160, v161, v162
    v_max3_u32 v12, v12, v163, v164
    v_max3_u32 v12, v12, v165, v166
    v_max_u32 v12, v12, v167
    v_cmp_eq_u32 vcc, -1, v12
    v_mfma_f32_32x32x16_bf16 v[96:111], v[152:155], a[140:143], v[96:111]
    v_mfma_f32_32x32x16_bf16 v[112:127], v[156:159], a[140:143], v[112:127]
    s_nop 2
    s_cbranch_vccnz L_rt133
L_rb134:
    v_mfma_f32_32x32x16_bf16 v[64:79], v[160:163], a[144:147], v[64:79]
    buffer_load_dwordx4 v[200:203], v8, s[32:35], s73 offen sc1
    v_mfma_f32_32x32x16_bf16 v[80:95], v[164:167], a[144:147], v[80:95]
    buffer_load_dwordx4 v[204:207], v9, s[32:35], s73 offen sc1
    s_add_u32 s73, s73, 16384
    s_waitcnt vmcnt(8)
    v_max3_u32 v12, v168, v169, v170
    v_max3_u32 v12, v12, v171, v172
    v_max3_u32 v12, v12, v173, v174
    v_max_u32 v12, v12, v175
    v_cmp_eq_u32 vcc, -1, v12
    v_mfma_f32_32x32x16_bf16 v[96:111], v[160:163], a[148:151], v[96:111]
    v_mfma_f32_32x32x16_bf16 v[112:127], v[164:167], a[148:151], v[112:127]
    s_nop 2
    s_cbranch_vccnz L_rt135
L_rb136:
    v_mfma_f32_32x32x16_bf16 v[64:79], v[168:171], a[152:155], v[64:79]
    buffer_load_dwordx4 v[208:211], v8, s[32:35], s73 offen sc1
    v_mfma_f32_32x32x16_bf16 v[80:95], v[172:175], a[152:155], v[80:95]
    buffer_load_dwordx4 v[212:215], v9, s[32:35], s73 offen sc1
    s_add_u32 s73, s73, 16384
    s_waitcnt vmcnt(8)
    v_max3_u32 v12, v176, v177, v178
    v_max3_u32 v12, v12, v179, v180
    v_max3_u32 v12, v12, v181, v182
    v_max_u32 v12, v12, v183
    v_cmp_eq_u32 vcc, -1, v12
    v_mfma_f32_32x32x16_bf16 v[96:111], v[168:171], a[156:159], v[96:111]
    v_mfma_f32_32x32x16_bf16 v[112:127], v[172:175], a[156:159], v[112:127]
    s_nop 2
    s_cbranch_vccnz L_rt137
L_rb138:
    v_mfma_f32_32x32x16_bf16 v[64:79], v[176:179], a[160:163], v[64:79]
    buffer_load_dwordx4 v[216:219], v8, s[32:35], s73 offen sc1
    v_mfma_f32_32x32x16_bf16 v[80:95], v[180:183], a[160:163], v[80:95]
    buffer_load_dwordx4 v[220:223], v9, s[32:35], s73 offen sc1
    s_add_u32 s73, s73, 16384
    s_waitcnt vmcnt(8)
    v_max3_u32 v12, v184, v185, v186
    v_max3_u32 v12, v12, v187, v188
    v_max3_u32 v12, v12, v189, v190
    v_max_u32 v12, v12, v191
    v_cmp_eq_u32 vcc, -1, v12
    v_mfma_f32_32x32x16_bf16 v[96:111], v[176:179], a[164:167], v[96:111]
    v_mfma_f32_32x32x16_bf16 v[112:127], v[180:183], a[164:167], v[112:127]
    s_nop 2
    s_cbranch_vccnz L_rt139
L_rb140:
    v_mfma_f32_32x32x16_bf16 v[64:79], v[184:187], a[168:171], v[64:79]
    buffer_load_dwordx4 v[224:227], v8, s[32:35], s73 offen sc1
    v_mfma_f32_32x32x16_bf16 v[80:95], v[188:191], a[168:171], v[80:95]
    buffer_load_dwordx4 v[228:231], v9, s[32:35], s73 offen sc1
    s_add_u32 s73, s73, 16384
    s_waitcnt vmcnt(8)
    v_max3_u32 v12, v192, v193, v194
    v_max3_u32 v12, v12, v195, v196
    v_max3_u32 v12, v12, v197, v198
    v_max_u32 v12, v12, v199
    v_cmp_eq_u32 vcc, -1, v12
    v_mfma_f32_32x32x16_bf16 v[96:111], v[184:187], a[172:175], v[96:111]
    v_mfma_f32_32x32x16_bf16 v[112:127], v[188:191], a[172:175], v[112:127]
    s_nop 2
    s_cbranch_vccnz L_rt141
L_rb142:
    v_mfma_f32_32x32x16_bf16 v[64:79], v[192:195], a[176:179], v[64:79]
    buffer_load_dwordx4 v[232:235], v8, s[32:35], s73 offen sc1
    v_mfma_f32_32x32x16_bf16 v[80:95], v[196:199], a[176:179], v[80:95]
    buffer_load_dwordx4 v[236:239], v9, s[32:35], s73 offen sc1
    s_add_u32 s73, s73, 16384
    s_waitcnt vmcnt(8)
    v_max3_u32 v12, v200, v201, v202
    v_max3_u32 v12, v12, v203, v204
    v_max3_u32 v12, v12, v205, v206
    v_max_u32 v12, v12, v207
    v_cmp_eq_u32 vcc, -1, v12
    v_mfma_f32_32x32x16_bf16 v[96:111], v[192:195], a[180:183], v[96:111]
    v_mfma_f32_32x32x16_bf16 v[112:127], v[196:199], a[180:183], v[112:127]
    s_nop 2
    s_cbranch_vccnz L_rt143
L_rb144:
    v_mfma_f32_32x32x16_bf16 v[64:79], v[200:203], a[184:187], v[64:79]
    v_mfma_f32_32x32x16_bf16 v[80:95], v[204:207], a[184:187], v[80:95]
    s_waitcnt vmcnt(6)
    v_max3_u32 v12, v208, v209, v210
    v_max3_u32 v12, v12, v211, v212
    v_max3_u32 v12, v12, v213, v214
    v_max_u32 v12, v12, v215
    v_cmp_eq_u32 vcc, -1, v12
    v_mfma_f32_32x32x16_bf16 v[96:111], v[200:203], a[188:191], v[96:111]
    v_mfma_f32_32x32x16_bf16 v[112:127], v[204:207], a[188:191], v[112:127]
    s_nop 2
    s_cbranch_vccnz L_rt145
L_rb146:
    v_mfma_f32_32x32x16_bf16 v[64:79], v[208:211], a[192:195], v[64:79]
    v_mfma_f32_32x32x16_bf16 v[80:95], v[212:215], a[192:195], v[80:95]
    s_waitcnt vmcnt(4)
    v_max3_u32 v12, v216, v217, v218
    v_max3_u32 v12, v12, v219, v220
    v_max3_u32 v12, v12, v221, v222
    v_max_u32 v12, v12, v223
    v_cmp_eq_u32 vcc, -1, v12
    v_mfma_f32_32x32x16_bf16 v[96:111], v[208:211], a[196:199], v[96:111]
    v_mfma_f32_32x32x16_bf16 v[112:127], v[212:215], a[196:199], v[112:127]
    s_nop 2
    s_cbranch_vccnz L_rt147
L_rb148:
    v_mfma_f32_32x32x16_bf16 v[64:79], v[216:219], a[200:203], v[64:79]
    v_mfma_f32_32x32x16_bf16 v[80:95], v[220:223], a[200:203], v[80:95]
    s_waitcnt vmcnt(2)
    v_max3_u32 v12, v224, v225, v226
    v_max3_u32 v12, v12, v227, v228
    v_max3_u32 v12, v12, v229, v230
    v_max_u32 v12, v12, v231
    v_cmp_eq_u32 vcc, -1, v12
    v_mfma_f32_32x32x16_bf16 v[96:111], v[216:219], a[204:207], v[96:111]
    v_mfma_f32_32x32x16_bf16 v[112:127], v[220:223], a[204:207], v[112:127]
    s_nop 2
    s_cbranch_vccnz L_rt149
L_rb150:
    v_mfma_f32_32x32x16_bf16 v[64:79], v[224:227], a[208:211], v[64:79]
    v_mfma_f32_32x32x16_bf16 v[80:95], v[228:231], a[208:211], v[80:95]
    s_waitcnt vmcnt(0)
    v_max3_u32 v12, v232, v233, v234
    v_max3_u32 v12, v12, v235, v236
    v_max3_u32 v12, v12, v237, v238
    v_max_u32 v12, v12, v239
    v_cmp_eq_u32 vcc, -1, v12
    v_mfma_f32_32x32x16_bf16 v[96:111], v[224:227], a[212:215], v[96:111]
    v_mfma_f32_32x32x16_bf16 v[112:127], v[228:231], a[212:215], v[112:127]
    s_nop 2
    s_cbranch_vccnz L_rt151
L_rb152:
    v_mfma_f32_32x32x16_bf16 v[64:79], v[232:235], a[216:219], v[64:79]
    v_mfma_f32_32x32x16_bf16 v[80:95], v[236:239], a[216:219], v[80:95]
    v_mfma_f32_32x32x16_bf16 v[96:111], v[232:235], a[220:223], v[96:111]
    v_mfma_f32_32x32x16_bf16 v[112:127], v[236:239], a[220:223], v[112:127]
    v_lshlrev_b32 v13, 4, v2
    s_xor_b32 s60, s10, 1
    s_mul_i32 s60, s60, 12288
    s_add_u32 s60, s60, 0
    v_add_u32 v14, s60, v13
    s_nop 4
    ds_write_b128 v14, v[80:83] offset:0
    ds_write_b128 v14, v[84:87] offset:1024
    ds_write_b128 v14, v[88:91] offset:2048
    ds_write_b128 v14, v[92:95] offset:3072
    s_xor_b32 s60, s10, 2
    s_mul_i32 s60, s60, 12288
    s_add_u32 s60, s60, 4096
    v_add_u32 v14, s60, v13
    ds_write_b128 v14, v[96:99] offset:0
    ds_write_b128 v14, v[100:103] offset:1024
    ds_write_b128 v14, v[104:107] offset:2048
    ds_write_b128 v14, v[108:111] offset:3072
    s_xor_b32 s60, s10, 3
    s_mul_i32 s60, s60, 12288
    s_add_u32 s60, s60, 8192
    v_add_u32 v14, s60, v13
    ds_write_b128 v14, v[112:115] offset:0
    ds_write_b128 v14, v[116:119] offset:1024
    ds_write_b128 v14, v[120:123] offset:2048
    ds_write_b128 v14, v[124:127] offset:3072
    s_waitcnt lgkmcnt(0)
    s_barrier
    s_mul_i32 s60, s10, 12288
    v_add_u32_e64 v14, s60, v13
    ds_read_b128 v[128:131], v14 offset:0
    ds_read_b128 v[132:135], v14 offset:1024
    ds_read_b128 v[136:139], v14 offset:2048
    ds_read_b128 v[140:143], v14 offset:3072
    ds_read_b128 v[144:147], v14 offset:4096
    ds_read_b128 v[148:151], v14 offset:5120
    ds_read_b128 v[152:155], v14 offset:6144
    ds_read_b128 v[156:159], v14 offset:7168
    ds_read_b128 v[160:163], v14 offset:8192
    ds_read_b128 v[164:167], v14 offset:9216
    ds_read_b128 v[168:171], v14 offset:10240
    ds_read_b128 v[172:175], v14 offset:11264
    s_waitcnt lgkmcnt(8)
    s_nop 0
    v_pk_add_f32 v[64:65], v[64:65], v[128:129]
    v_pk_add_f32 v[66:67], v[66:67], v[130:131]
    v_pk_add_f32 v[68:69], v[68:69], v[132:133]
    v_pk_add_f32 v[70:71], v[70:71], v[134:135]
    v_pk_add_f32 v[72:73], v[72:73], v[136:137]
    v_pk_add_f32 v[74:75], v[74:75], v[138:139]
    v_pk_add_f32 v[76:77], v[76:77], v[140:141]
    v_pk_add_f32 v[78:79], v[78:79], v[142:143]
    s_waitcnt lgkmcnt(0)
    s_nop 0
    v_pk_add_f32 v[144:145], v[144:145], v[160:161]
    v_pk_add_f32 v[146:147], v[146:147], v[162:163]
    v_pk_add_f32 v[148:149], v[148:149], v[164:165]
    v_pk_add_f32 v[150:151], v[150:151], v[166:167]
    v_pk_add_f32 v[152:153], v[152:153], v[168:169]
    v_pk_add_f32 v[154:155], v[154:155], v[170:171]
    v_pk_add_f32 v[156:157], v[156:157], v[172:173]
    v_pk_add_f32 v[158:159], v[158:159], v[174:175]
    v_pk_add_f32 v[128:129], v[64:65], v[144:145]
    v_pk_add_f32 v[130:131], v[66:67], v[146:147]
    v_pk_add_f32 v[132:133], v[68:69], v[148:149]
    v_pk_add_f32 v[134:135], v[70:71], v[150:151]
    v_pk_add_f32 v[136:137], v[72:73], v[152:153]
    v_pk_add_f32 v[138:139], v[74:75], v[154:155]
    v_pk_add_f32 v[140:141], v[76:77], v[156:157]
    v_pk_add_f32 v[142:143], v[78:79], v[158:159]
    v_cvt_pk_bf16_f32 v144, v128, v132
    v_cvt_pk_bf16_f32 v145, v136, v140
    v_cvt_pk_bf16_f32 v146, v129, v133
    v_cvt_pk_bf16_f32 v147, v137, v141
    v_cvt_pk_bf16_f32 v148, v130, v134
    v_cvt_pk_bf16_f32 v149, v138, v142
    v_cvt_pk_bf16_f32 v150, v131, v135
    v_cvt_pk_bf16_f32 v151, v139, v143
    v_lshlrev_b32_e64 v160, 16, v144
    v_and_b32 v161, 0xffff0000, v144
    v_lshlrev_b32_e64 v162, 16, v145
    v_and_b32 v163, 0xffff0000, v145
    v_lshlrev_b32_e64 v164, 16, v146
    v_and_b32 v165, 0xffff0000, v146
    v_lshlrev_b32_e64 v166, 16, v147
    v_and_b32 v167, 0xffff0000, v147
    v_lshlrev_b32_e64 v168, 16, v148
    v_and_b32 v169, 0xffff0000, v148
    v_lshlrev_b32_e64 v170, 16, v149
    v_and_b32 v171, 0xffff0000, v149
    v_lshlrev_b32_e64 v172, 16, v150
    v_and_b32 v173, 0xffff0000, v150
    v_lshlrev_b32_e64 v174, 16, v151
    v_and_b32 v175, 0xffff0000, v151
    v_pk_add_f32 v[160:161], v[160:161], v[18:19]
    v_pk_add_f32 v[162:163], v[162:163], v[18:19]
    v_pk_add_f32 v[164:165], v[164:165], v[18:19]
    v_pk_add_f32 v[166:167], v[166:167], v[18:19]
    v_pk_add_f32 v[168:169], v[168:169], v[18:19]
    v_pk_add_f32 v[170:171], v[170:171], v[18:19]
    v_pk_add_f32 v[172:173], v[172:173], v[18:19]
    v_pk_add_f32 v[174:175], v[174:175], v[18:19]
    v_cvt_pk_bf16_f32 v144, v160, v161
    v_cvt_pk_bf16_f32 v145, v162, v163
    v_cvt_pk_bf16_f32 v146, v164, v165
    v_cvt_pk_bf16_f32 v147, v166, v167
    v_cvt_pk_bf16_f32 v148, v168, v169
    v_cvt_pk_bf16_f32 v149, v170, v171
    v_cvt_pk_bf16_f32 v150, v172, v173
    v_cvt_pk_bf16_f32 v151, v174, v175
    ds_write_b64 v44, v[144:145] offset:0
    ds_write_b64 v44, v[146:147] offset:16
    ds_write_b64 v44, v[148:149] offset:32
    ds_write_b64 v44, v[150:151] offset:48
    s_waitcnt lgkmcnt(0)
    s_barrier
    ds_read_b128 v[144:147], v45
    ds_read_b128 v[148:151], v45 offset:4608
    s_waitcnt lgkmcnt(0)
    v_lshlrev_b32 v160, 16, v144
    v_and_b32 v161, 0xffff0000, v144
    v_lshlrev_b32_e64 v162, 16, v145
    v_and_b32 v163, 0xffff0000, v145
    v_lshlrev_b32_e64 v164, 16, v146
    v_and_b32 v165, 0xffff0000, v146
    v_lshlrev_b32_e64 v166, 16, v147
    v_and_b32 v167, 0xffff0000, v147
    v_lshlrev_b32_e64 v168, 16, v148
    v_and_b32 v169, 0xffff0000, v148
    v_lshlrev_b32_e64 v170, 16, v149
    v_and_b32 v171, 0xffff0000, v149
    v_lshlrev_b32_e64 v172, 16, v150
    v_and_b32 v173, 0xffff0000, v150
    v_lshlrev_b32_e64 v174, 16, v151
    v_and_b32 v175, 0xffff0000, v151
    v_pk_add_f32 v[160:161], v[160:161], v[28:29]
    v_pk_add_f32 v[162:163], v[162:163], v[30:31]
    v_pk_add_f32 v[164:165], v[164:165], v[32:33]
    v_pk_add_f32 v[166:167], v[166:167], v[34:35]
    v_pk_add_f32 v[168:169], v[168:169], v[36:37]
    v_pk_add_f32 v[170:171], v[170:171], v[38:39]
    v_pk_add_f32 v[172:173], v[172:173], v[40:41]
    v_pk_add_f32 v[174:175], v[174:175], v[42:43]
    v_cvt_pk_bf16_f32 v144, v160, v161
    v_cvt_pk_bf16_f32 v145, v162, v163
    v_cvt_pk_bf16_f32 v146, v164, v165
    v_cvt_pk_bf16_f32 v147, v166, v167
    v_cvt_pk_bf16_f32 v148, v168, v169
    v_cvt_pk_bf16_f32 v149, v170, v171
    v_cvt_pk_bf16_f32 v150, v172, v173
    v_cvt_pk_bf16_f32 v151, v174, v175
    buffer_store_dwordx4 v[144:147], v16, s[44:47], s70 offen sc1
    buffer_store_dwordx4 v[148:151], v16, s[44:47], s74 offen sc1
L_exit:
    s_endpgm
L_rt32:
    s_mov_b32 s61, 0
    s_add_u32 s62, s71, 0
L_rt32_l:
    buffer_load_dwordx4 v[128:131], v8, s[28:31], s62 offen sc1
    buffer_load_dwordx4 v[132:135], v9, s[28:31], s62 offen sc1
    s_add_u32 s61, s61, 1
    s_waitcnt vmcnt(0)
    v_max3_u32 v12, v128, v129, v130
    v_max3_u32 v12, v12, v131, v132
    v_max3_u32 v12, v12, v133, v134
    v_max_u32 v12, v12, v135
    v_cmp_eq_u32 vcc, -1, v12
    s_nop 4
    s_cbranch_vccz L_rb33
    s_cmp_lt_u32 s61, 131072
    s_cbranch_scc1 L_rt32_l
    s_branch L_rb33
L_rt34:
    s_mov_b32 s61, 0
    s_add_u32 s62, s71, 16384
L_rt34_l:
    buffer_load_dwordx4 v[136:139], v8, s[28:31], s62 offen sc1
    buffer_load_dwordx4 v[140:143], v9, s[28:31], s62 offen sc1
    s_add_u32 s61, s61, 1
    s_waitcnt vmcnt(0)
    v_max3_u32 v12, v136, v137, v138
    v_max3_u32 v12, v12, v139, v140
    v_max3_u32 v12, v12, v141, v142
    v_max_u32 v12, v12, v143
    v_cmp_eq_u32 vcc, -1, v12
    s_nop 4
    s_cbranch_vccz L_rb35
    s_cmp_lt_u32 s61, 131072
    s_cbranch_scc1 L_rt34_l
    s_branch L_rb35
L_rt36:
    s_mov_b32 s61, 0
    s_add_u32 s62, s71, 32768
L_rt36_l:
    buffer_load_dwordx4 v[144:147], v8, s[28:31], s62 offen sc1
    buffer_load_dwordx4 v[148:151], v9, s[28:31], s62 offen sc1
    s_add_u32 s61, s61, 1
    s_waitcnt vmcnt(0)
    v_max3_u32 v12, v144, v145, v146
    v_max3_u32 v12, v12, v147, v148
    v_max3_u32 v12, v12, v149, v150
    v_max_u32 v12, v12, v151
    v_cmp_eq_u32 vcc, -1, v12
    s_nop 4
    s_cbranch_vccz L_rb37
    s_cmp_lt_u32 s61, 131072
    s_cbranch_scc1 L_rt36_l
    s_branch L_rb37
L_rt38:
    s_mov_b32 s61, 0
    s_add_u32 s62, s71, 49152
L_rt38_l:
    buffer_load_dwordx4 v[152:155], v8, s[28:31], s62 offen sc1
    buffer_load_dwordx4 v[156:159], v9, s[28:31], s62 offen sc1
    s_add_u32 s61, s61, 1
    s_waitcnt vmcnt(0)
    v_max3_u32 v12, v152, v153, v154
    v_max3_u32 v12, v12, v155, v156
    v_max3_u32 v12, v12, v157, v158
    v_max_u32 v12, v12, v159
    v_cmp_eq_u32 vcc, -1, v12
    s_nop 4
    s_cbranch_vccz L_rb39
    s_cmp_lt_u32 s61, 131072
    s_cbranch_scc1 L_rt38_l
    s_branch L_rb39
L_rt40:
    s_mov_b32 s61, 0
    s_add_u32 s62, s71, 65536
L_rt40_l:
    buffer_load_dwordx4 v[160:163], v8, s[28:31], s62 offen sc1
    buffer_load_dwordx4 v[164:167], v9, s[28:31], s62 offen sc1
    s_add_u32 s61, s61, 1
    s_waitcnt vmcnt(0)
    v_max3_u32 v12, v160, v161, v162
    v_max3_u32 v12, v12, v163, v164
    v_max3_u32 v12, v12, v165, v166
    v_max_u32 v12, v12, v167
    v_cmp_eq_u32 vcc, -1, v12
    s_nop 4
    s_cbranch_vccz L_rb41
    s_cmp_lt_u32 s61, 131072
    s_cbranch_scc1 L_rt40_l
    s_branch L_rb41
L_rt42:
    s_mov_b32 s61, 0
    s_add_u32 s62, s71, 81920
L_rt42_l:
    buffer_load_dwordx4 v[168:171], v8, s[28:31], s62 offen sc1
    buffer_load_dwordx4 v[172:175], v9, s[28:31], s62 offen sc1
    s_add_u32 s61, s61, 1
    s_waitcnt vmcnt(0)
    v_max3_u32 v12, v168, v169, v170
    v_max3_u32 v12, v12, v171, v172
    v_max3_u32 v12, v12, v173, v174
    v_max_u32 v12, v12, v175
    v_cmp_eq_u32 vcc, -1, v12
    s_nop 4
    s_cbranch_vccz L_rb43
    s_cmp_lt_u32 s61, 131072
    s_cbranch_scc1 L_rt42_l
    s_branch L_rb43
L_rt44:
    s_mov_b32 s61, 0
    s_add_u32 s62, s71, 98304
L_rt44_l:
    buffer_load_dwordx4 v[176:179], v8, s[28:31], s62 offen sc1
    buffer_load_dwordx4 v[180:183], v9, s[28:31], s62 offen sc1
    s_add_u32 s61, s61, 1
    s_waitcnt vmcnt(0)
    v_max3_u32 v12, v176, v177, v178
    v_max3_u32 v12, v12, v179, v180
    v_max3_u32 v12, v12, v181, v182
    v_max_u32 v12, v12, v183
    v_cmp_eq_u32 vcc, -1, v12
    s_nop 4
    s_cbranch_vccz L_rb45
    s_cmp_lt_u32 s61, 131072
    s_cbranch_scc1 L_rt44_l
    s_branch L_rb45
L_rt46:
    s_mov_b32 s61, 0
    s_add_u32 s62, s71, 114688
L_rt46_l:
    buffer_load_dwordx4 v[184:187], v8, s[28:31], s62 offen sc1
    buffer_load_dwordx4 v[188:191], v9, s[28:31], s62 offen sc1
    s_add_u32 s61, s61, 1
    s_waitcnt vmcnt(0)
    v_max3_u32 v12, v184, v185, v186
    v_max3_u32 v12, v12, v187, v188
    v_max3_u32 v12, v12, v189, v190
    v_max_u32 v12, v12, v191
    v_cmp_eq_u32 vcc, -1, v12
    s_nop 4
    s_cbranch_vccz L_rb47
    s_cmp_lt_u32 s61, 131072
    s_cbranch_scc1 L_rt46_l
    s_branch L_rb47
L_rt48:
    s_mov_b32 s61, 0
    s_add_u32 s62, s71, 131072
L_rt48_l:
    buffer_load_dwordx4 v[192:195], v8, s[28:31], s62 offen sc1
    buffer_load_dwordx4 v[196:199], v9, s[28:31], s62 offen sc1
    s_add_u32 s61, s61, 1
    s_waitcnt vmcnt(0)
    v_max3_u32 v12, v192, v193, v194
    v_max3_u32 v12, v12, v195, v196
    v_max3_u32 v12, v12, v197, v198
    v_max_u32 v12, v12, v199
    v_cmp_eq_u32 vcc, -1, v12
    s_nop 4
    s_cbranch_vccz L_rb49
    s_cmp_lt_u32 s61, 131072
    s_cbranch_scc1 L_rt48_l
    s_branch L_rb49
L_rt50:
    s_mov_b32 s61, 0
    s_add_u32 s62, s71, 147456
L_rt50_l:
    buffer_load_dwordx4 v[200:203], v8, s[28:31], s62 offen sc1
    buffer_load_dwordx4 v[204:207], v9, s[28:31], s62 offen sc1
    s_add_u32 s61, s61, 1
    s_waitcnt vmcnt(0)
    v_max3_u32 v12, v200, v201, v202
    v_max3_u32 v12, v12, v203, v204
    v_max3_u32 v12, v12, v205, v206
    v_max_u32 v12, v12, v207
    v_cmp_eq_u32 vcc, -1, v12
    s_nop 4
    s_cbranch_vccz L_rb51
    s_cmp_lt_u32 s61, 131072
    s_cbranch_scc1 L_rt50_l
    s_branch L_rb51
L_rt52:
    s_mov_b32 s61, 0
    s_add_u32 s62, s71, 163840
L_rt52_l:
    buffer_load_dwordx4 v[208:211], v8, s[28:31], s62 offen sc1
    buffer_load_dwordx4 v[212:215], v9, s[28:31], s62 offen sc1
    s_add_u32 s61, s61, 1
    s_waitcnt vmcnt(0)
    v_max3_u32 v12, v208, v209, v210
    v_max3_u32 v12, v12, v211, v212
    v_max3_u32 v12, v12, v213, v214
    v_max_u32 v12, v12, v215
    v_cmp_eq_u32 vcc, -1, v12
    s_nop 4
    s_cbranch_vccz L_rb53
    s_cmp_lt_u32 s61, 131072
    s_cbranch_scc1 L_rt52_l
    s_branch L_rb53
L_rt54:
    s_mov_b32 s61, 0
    s_add_u32 s62, s71, 180224
L_rt54_l:
    buffer_load_dwordx4 v[216:219], v8, s[28:31], s62 offen sc1
    buffer_load_dwordx4 v[220:223], v9, s[28:31], s62 offen sc1
    s_add_u32 s61, s61, 1
    s_waitcnt vmcnt(0)
    v_max3_u32 v12, v216, v217, v218
    v_max3_u32 v12, v12, v219, v220
    v_max3_u32 v12, v12, v221, v222
    v_max_u32 v12, v12, v223
    v_cmp_eq_u32 vcc, -1, v12
    s_nop 4
    s_cbranch_vccz L_rb55
    s_cmp_lt_u32 s61, 131072
    s_cbranch_scc1 L_rt54_l
    s_branch L_rb55
L_rt56:
    s_mov_b32 s61, 0
    s_add_u32 s62, s71, 196608
L_rt56_l:
    buffer_load_dwordx4 v[224:227], v8, s[28:31], s62 offen sc1
    buffer_load_dwordx4 v[228:231], v9, s[28:31], s62 offen sc1
    s_add_u32 s61, s61, 1
    s_waitcnt vmcnt(0)
    v_max3_u32 v12, v224, v225, v226
    v_max3_u32 v12, v12, v227, v228
    v_max3_u32 v12, v12, v229, v230
    v_max_u32 v12, v12, v231
    v_cmp_eq_u32 vcc, -1, v12
    s_nop 4
    s_cbranch_vccz L_rb57
    s_cmp_lt_u32 s61, 131072
    s_cbranch_scc1 L_rt56_l
    s_branch L_rb57
L_rt58:
    s_mov_b32 s61, 0
    s_add_u32 s62, s71, 212992
L_rt58_l:
    buffer_load_dwordx4 v[232:235], v8, s[28:31], s62 offen sc1
    buffer_load_dwordx4 v[236:239], v9, s[28:31], s62 offen sc1
    s_add_u32 s61, s61, 1
    s_waitcnt vmcnt(0)
    v_max3_u32 v12, v232, v233, v234
    v_max3_u32 v12, v12, v235, v236
    v_max3_u32 v12, v12, v237, v238
    v_max_u32 v12, v12, v239
    v_cmp_eq_u32 vcc, -1, v12
    s_nop 4
    s_cbranch_vccz L_rb59
    s_cmp_lt_u32 s61, 131072
    s_cbranch_scc1 L_rt58_l
    s_branch L_rb59
L_rt60:
    s_mov_b32 s61, 0
    s_add_u32 s62, s71, 229376
L_rt60_l:
    buffer_load_dwordx4 v[128:131], v8, s[28:31], s62 offen sc1
    buffer_load_dwordx4 v[132:135], v9, s[28:31], s62 offen sc1
    s_add_u32 s61, s61, 1
    s_waitcnt vmcnt(0)
    v_max3_u32 v12, v128, v129, v130
    v_max3_u32 v12, v12, v131, v132
    v_max3_u32 v12, v12, v133, v134
    v_max_u32 v12, v12, v135
    v_cmp_eq_u32 vcc, -1, v12
    s_nop 4
    s_cbranch_vccz L_rb61
    s_cmp_lt_u32 s61, 131072
    s_cbranch_scc1 L_rt60_l
    s_branch L_rb61
L_rt62:
    s_mov_b32 s61, 0
    s_add_u32 s62, s71, 245760
L_rt62_l:
    buffer_load_dwordx4 v[136:139], v8, s[28:31], s62 offen sc1
    buffer_load_dwordx4 v[140:143], v9, s[28:31], s62 offen sc1
    s_add_u32 s61, s61, 1
    s_waitcnt vmcnt(0)
    v_max3_u32 v12, v136, v137, v138
    v_max3_u32 v12, v12, v139, v140
    v_max3_u32 v12, v12, v141, v142
    v_max_u32 v12, v12, v143
    v_cmp_eq_u32 vcc, -1, v12
    s_nop 4
    s_cbranch_vccz L_rb63
    s_cmp_lt_u32 s61, 131072
    s_cbranch_scc1 L_rt62_l
    s_branch L_rb63
L_rt64:
    s_mov_b32 s61, 0
    s_add_u32 s62, s71, 262144
L_rt64_l:
    buffer_load_dwordx4 v[144:147], v8, s[28:31], s62 offen sc1
    buffer_load_dwordx4 v[148:151], v9, s[28:31], s62 offen sc1
    s_add_u32 s61, s61, 1
    s_waitcnt vmcnt(0)
    v_max3_u32 v12, v144, v145, v146
    v_max3_u32 v12, v12, v147, v148
    v_max3_u32 v12, v12, v149, v150
    v_max_u32 v12, v12, v151
    v_cmp_eq_u32 vcc, -1, v12
    s_nop 4
    s_cbranch_vccz L_rb65
    s_cmp_lt_u32 s61, 131072
    s_cbranch_scc1 L_rt64_l
    s_branch L_rb65
L_rt66:
    s_mov_b32 s61, 0
    s_add_u32 s62, s71, 278528
L_rt66_l:
    buffer_load_dwordx4 v[152:155], v8, s[28:31], s62 offen sc1
    buffer_load_dwordx4 v[156:159], v9, s[28:31], s62 offen sc1
    s_add_u32 s61, s61, 1
    s_waitcnt vmcnt(0)
    v_max3_u32 v12, v152, v153, v154
    v_max3_u32 v12, v12, v155, v156
    v_max3_u32 v12, v12, v157, v158
    v_max_u32 v12, v12, v159
    v_cmp_eq_u32 vcc, -1, v12
    s_nop 4
    s_cbranch_vccz L_rb67
    s_cmp_lt_u32 s61, 131072
    s_cbranch_scc1 L_rt66_l
    s_branch L_rb67
L_rt68:
    s_mov_b32 s61, 0
    s_add_u32 s62, s71, 294912
L_rt68_l:
    buffer_load_dwordx4 v[160:163], v8, s[28:31], s62 offen sc1
    buffer_load_dwordx4 v[164:167], v9, s[28:31], s62 offen sc1
    s_add_u32 s61, s61, 1
    s_waitcnt vmcnt(0)
    v_max3_u32 v12, v160, v161, v162
    v_max3_u32 v12, v12, v163, v164
    v_max3_u32 v12, v12, v165, v166
    v_max_u32 v12, v12, v167
    v_cmp_eq_u32 vcc, -1, v12
    s_nop 4
    s_cbranch_vccz L_rb69
    s_cmp_lt_u32 s61, 131072
    s_cbranch_scc1 L_rt68_l
    s_branch L_rb69
L_rt70:
    s_mov_b32 s61, 0
    s_add_u32 s62, s71, 311296
L_rt70_l:
    buffer_load_dwordx4 v[168:171], v8, s[28:31], s62 offen sc1
    buffer_load_dwordx4 v[172:175], v9, s[28:31], s62 offen sc1
    s_add_u32 s61, s61, 1
    s_waitcnt vmcnt(0)
    v_max3_u32 v12, v168, v169, v170
    v_max3_u32 v12, v12, v171, v172
    v_max3_u32 v12, v12, v173, v174
    v_max_u32 v12, v12, v175
    v_cmp_eq_u32 vcc, -1, v12
    s_nop 4
    s_cbranch_vccz L_rb71
    s_cmp_lt_u32 s61, 131072
    s_cbranch_scc1 L_rt70_l
    s_branch L_rb71
L_rt72:
    s_mov_b32 s61, 0
    s_add_u32 s62, s71, 327680
L_rt72_l:
    buffer_load_dwordx4 v[176:179], v8, s[28:31], s62 offen sc1
    buffer_load_dwordx4 v[180:183], v9, s[28:31], s62 offen sc1
    s_add_u32 s61, s61, 1
    s_waitcnt vmcnt(0)
    v_max3_u32 v12, v176, v177, v178
    v_max3_u32 v12, v12, v179, v180
    v_max3_u32 v12, v12, v181, v182
    v_max_u32 v12, v12, v183
    v_cmp_eq_u32 vcc, -1, v12
    s_nop 4
    s_cbranch_vccz L_rb73
    s_cmp_lt_u32 s61, 131072
    s_cbranch_scc1 L_rt72_l
    s_branch L_rb73
L_rt74:
    s_mov_b32 s61, 0
    s_add_u32 s62, s71, 344064
L_rt74_l:
    buffer_load_dwordx4 v[184:187], v8, s[28:31], s62 offen sc1
    buffer_load_dwordx4 v[188:191], v9, s[28:31], s62 offen sc1
    s_add_u32 s61, s61, 1
    s_waitcnt vmcnt(0)
    v_max3_u32 v12, v184, v185, v186
    v_max3_u32 v12, v12, v187, v188
    v_max3_u32 v12, v12, v189, v190
    v_max_u32 v12, v12, v191
    v_cmp_eq_u32 vcc, -1, v12
    s_nop 4
    s_cbranch_vccz L_rb75
    s_cmp_lt_u32 s61, 131072
    s_cbranch_scc1 L_rt74_l
    s_branch L_rb75
L_rt76:
    s_mov_b32 s61, 0
    s_add_u32 s62, s71, 360448
L_rt76_l:
    buffer_load_dwordx4 v[192:195], v8, s[28:31], s62 offen sc1
    buffer_load_dwordx4 v[196:199], v9, s[28:31], s62 offen sc1
    s_add_u32 s61, s61, 1
    s_waitcnt vmcnt(0)
    v_max3_u32 v12, v192, v193, v194
    v_max3_u32 v12, v12, v195, v196
    v_max3_u32 v12, v12, v197, v198
    v_max_u32 v12, v12, v199
    v_cmp_eq_u32 vcc, -1, v12
    s_nop 4
    s_cbranch_vccz L_rb77
    s_cmp_lt_u32 s61, 131072
    s_cbranch_scc1 L_rt76_l
    s_branch L_rb77
L_rt78:
    s_mov_b32 s61, 0
    s_add_u32 s62, s71, 376832
L_rt78_l:
    buffer_load_dwordx4 v[200:203], v8, s[28:31], s62 offen sc1
    buffer_load_dwordx4 v[204:207], v9, s[28:31], s62 offen sc1
    s_add_u32 s61, s61, 1
    s_waitcnt vmcnt(0)
    v_max3_u32 v12, v200, v201, v202
    v_max3_u32 v12, v12, v203, v204
    v_max3_u32 v12, v12, v205, v206
    v_max_u32 v12, v12, v207
    v_cmp_eq_u32 vcc, -1, v12
    s_nop 4
    s_cbranch_vccz L_rb79
    s_cmp_lt_u32 s61, 131072
    s_cbranch_scc1 L_rt78_l
    s_branch L_rb79
L_rt80:
    s_mov_b32 s61, 0
    s_add_u32 s62, s71, 393216
L_rt80_l:
    buffer_load_dwordx4 v[208:211], v8, s[28:31], s62 offen sc1
    buffer_load_dwordx4 v[212:215], v9, s[28:31], s62 offen sc1
    s_add_u32 s61, s61, 1
    s_waitcnt vmcnt(0)
    v_max3_u32 v12, v208, v209, v210
    v_max3_u32 v12, v12, v211, v212
    v_max3_u32 v12, v12, v213, v214
    v_max_u32 v12, v12, v215
    v_cmp_eq_u32 vcc, -1, v12
    s_nop 4
    s_cbranch_vccz L_rb81
    s_cmp_lt_u32 s61, 131072
    s_cbranch_scc1 L_rt80_l
    s_branch L_rb81
L_rt82:
    s_mov_b32 s61, 0
    s_add_u32 s62, s71, 409600
L_rt82_l:
    buffer_load_dwordx4 v[216:219], v8, s[28:31], s62 offen sc1
    buffer_load_dwordx4 v[220:223], v9, s[28:31], s62 offen sc1
    s_add_u32 s61, s61, 1
    s_waitcnt vmcnt(0)
    v_max3_u32 v12, v216, v217, v218
    v_max3_u32 v12, v12, v219, v220
    v_max3_u32 v12, v12, v221, v222
    v_max_u32 v12, v12, v223
    v_cmp_eq_u32 vcc, -1, v12
    s_nop 4
    s_cbranch_vccz L_rb83
    s_cmp_lt_u32 s61, 131072
    s_cbranch_scc1 L_rt82_l
    s_branch L_rb83
L_rt84:
    s_mov_b32 s61, 0
    s_add_u32 s62, s71, 425984
L_rt84_l:
    buffer_load_dwordx4 v[224:227], v8, s[28:31], s62 offen sc1
    buffer_load_dwordx4 v[228:231], v9, s[28:31], s62 offen sc1
    s_add_u32 s61, s61, 1
    s_waitcnt vmcnt(0)
    v_max3_u32 v12, v224, v225, v226
    v_max3_u32 v12, v12, v227, v228
    v_max3_u32 v12, v12, v229, v230
    v_max_u32 v12, v12, v231
    v_cmp_eq_u32 vcc, -1, v12
    s_nop 4
    s_cbranch_vccz L_rb85
    s_cmp_lt_u32 s61, 131072
    s_cbranch_scc1 L_rt84_l
    s_branch L_rb85
L_rt86:
    s_mov_b32 s61, 0
    s_add_u32 s62, s71, 442368
L_rt86_l:
    buffer_load_dwordx4 v[232:235], v8, s[28:31], s62 offen sc1
    buffer_load_dwordx4 v[236:239], v9, s[28:31], s62 offen sc1
    s_add_u32 s61, s61, 1
    s_waitcnt vmcnt(0)
    v_max3_u32 v12, v232, v233, v234
    v_max3_u32 v12, v12, v235, v236
    v_max3_u32 v12, v12, v237, v238
    v_max_u32 v12, v12, v239
    v_cmp_eq_u32 vcc, -1, v12
    s_nop 4
    s_cbranch_vccz L_rb87
    s_cmp_lt_u32 s61, 131072
    s_cbranch_scc1 L_rt86_l
    s_branch L_rb87
L_rt88:
    s_mov_b32 s61, 0
    s_add_u32 s62, s71, 458752
L_rt88_l:
    buffer_load_dwordx4 v[128:131], v8, s[28:31], s62 offen sc1
    buffer_load_dwordx4 v[132:135], v9, s[28:31], s62 offen sc1
    s_add_u32 s61, s61, 1
    s_waitcnt vmcnt(0)
    v_max3_u32 v12, v128, v129, v130
    v_max3_u32 v12, v12, v131, v132
    v_max3_u32 v12, v12, v133, v134
    v_max_u32 v12, v12, v135
    v_cmp_eq_u32 vcc, -1, v12
    s_nop 4
    s_cbranch_vccz L_rb89
    s_cmp_lt_u32 s61, 131072
    s_cbranch_scc1 L_rt88_l
    s_branch L_rb89
L_rt90:
    s_mov_b32 s61, 0
    s_add_u32 s62, s71, 475136
L_rt90_l:
    buffer_load_dwordx4 v[136:139], v8, s[28:31], s62 offen sc1
    buffer_load_dwordx4 v[140:143], v9, s[28:31], s62 offen sc1
    s_add_u32 s61, s61, 1
    s_waitcnt vmcnt(0)
    v_max3_u32 v12, v136, v137, v138
    v_max3_u32 v12, v12, v139, v140
    v_max3_u32 v12, v12, v141, v142
    v_max_u32 v12, v12, v143
    v_cmp_eq_u32 vcc, -1, v12
    s_nop 4
    s_cbranch_vccz L_rb91
    s_cmp_lt_u32 s61, 131072
    s_cbranch_scc1 L_rt90_l
    s_branch L_rb91
L_rt92:
    s_mov_b32 s61, 0
    s_add_u32 s62, s71, 491520
L_rt92_l:
    buffer_load_dwordx4 v[144:147], v8, s[28:31], s62 offen sc1
    buffer_load_dwordx4 v[148:151], v9, s[28:31], s62 offen sc1
    s_add_u32 s61, s61, 1
    s_waitcnt vmcnt(0)
    v_max3_u32 v12, v144, v145, v146
    v_max3_u32 v12, v12, v147, v148
    v_max3_u32 v12, v12, v149, v150
    v_max_u32 v12, v12, v151
    v_cmp_eq_u32 vcc, -1, v12
    s_nop 4
    s_cbranch_vccz L_rb93
    s_cmp_lt_u32 s61, 131072
    s_cbranch_scc1 L_rt92_l
    s_branch L_rb93
L_rt94:
    s_mov_b32 s61, 0
    s_add_u32 s62, s71, 507904
L_rt94_l:
    buffer_load_dwordx4 v[152:155], v8, s[28:31], s62 offen sc1
    buffer_load_dwordx4 v[156:159], v9, s[28:31], s62 offen sc1
    s_add_u32 s61, s61, 1
    s_waitcnt vmcnt(0)
    v_max3_u32 v12, v152, v153, v154
    v_max3_u32 v12, v12, v155, v156
    v_max3_u32 v12, v12, v157, v158
    v_max_u32 v12, v12, v159
    v_cmp_eq_u32 vcc, -1, v12
    s_nop 4
    s_cbranch_vccz L_rb95
    s_cmp_lt_u32 s61, 131072
    s_cbranch_scc1 L_rt94_l
    s_branch L_rb95
L_rt97:
    s_mov_b32 s61, 0
    s_add_u32 s62, s71, 0
L_rt97_l:
    buffer_load_dwordx4 v[128:131], v8, s[32:35], s62 offen sc1
    buffer_load_dwordx4 v[132:135], v9, s[32:35], s62 offen sc1
    s_add_u32 s61, s61, 1
    s_waitcnt vmcnt(0)
    v_max3_u32 v12, v128, v129, v130
    v_max3_u32 v12, v12, v131, v132
    v_max3_u32 v12, v12, v133, v134
    v_max_u32 v12, v12, v135
    v_cmp_eq_u32 vcc, -1, v12
    s_nop 4
    s_cbranch_vccz L_rb98
    s_cmp_lt_u32 s61, 131072
    s_cbranch_scc1 L_rt97_l
    s_branch L_rb98
L_rt99:
    s_mov_b32 s61, 0
    s_add_u32 s62, s71, 16384
L_rt99_l:
    buffer_load_dwordx4 v[136:139], v8, s[32:35], s62 offen sc1
    buffer_load_dwordx4 v[140:143], v9, s[32:35], s62 offen sc1
    s_add_u32 s61, s61, 1
    s_waitcnt vmcnt(0)
    v_max3_u32 v12, v136, v137, v138
    v_max3_u32 v12, v12, v139, v140
    v_max3_u32 v12, v12, v141, v142
    v_max_u32 v12, v12, v143
    v_cmp_eq_u32 vcc, -1, v12
    s_nop 4
    s_cbranch_vccz L_rb100
    s_cmp_lt_u32 s61, 131072
    s_cbranch_scc1 L_rt99_l
    s_branch L_rb100
L_rt101:
    s_mov_b32 s61, 0
    s_add_u32 s62, s71, 32768
L_rt101_l:
    buffer_load_dwordx4 v[144:147], v8, s[32:35], s62 offen sc1
    buffer_load_dwordx4 v[148:151], v9, s[32:35], s62 offen sc1
    s_add_u32 s61, s61, 1
    s_waitcnt vmcnt(0)
    v_max3_u32 v12, v144, v145, v146
    v_max3_u32 v12, v12, v147, v148
    v_max3_u32 v12, v12, v149, v150
    v_max_u32 v12, v12, v151
    v_cmp_eq_u32 vcc, -1, v12
    s_nop 4
    s_cbranch_vccz L_rb102
    s_cmp_lt_u32 s61, 131072
    s_cbranch_scc1 L_rt101_l
    s_branch L_rb102
L_rt103:
    s_mov_b32 s61, 0
    s_add_u32 s62, s71, 49152
L_rt103_l:
    buffer_load_dwordx4 v[152:155], v8, s[32:35], s62 offen sc1
    buffer_load_dwordx4 v[156:159], v9, s[32:35], s62 offen sc1
    s_add_u32 s61, s61, 1
    s_waitcnt vmcnt(0)
    v_max3_u32 v12, v152, v153, v154
    v_max3_u32 v12, v12, v155, v156
    v_max3_u32 v12, v12, v157, v158
    v_max_u32 v12, v12, v159
    v_cmp_eq_u32 vcc, -1, v12
    s_nop 4
    s_cbranch_vccz L_rb104
    s_cmp_lt_u32 s61, 131072
    s_cbranch_scc1 L_rt103_l
    s_branch L_rb104
L_rt105:
    s_mov_b32 s61, 0
    s_add_u32 s62, s71, 65536
L_rt105_l:
    buffer_load_dwordx4 v[160:163], v8, s[32:35], s62 offen sc1
    buffer_load_dwordx4 v[164:167], v9, s[32:35], s62 offen sc1
    s_add_u32 s61, s61, 1
    s_waitcnt vmcnt(0)
    v_max3_u32 v12, v160, v161, v162
    v_max3_u32 v12, v12, v163, v164
    v_max3_u32 v12, v12, v165, v166
    v_max_u32 v12, v12, v167
    v_cmp_eq_u32 vcc, -1, v12
    s_nop 4
    s_cbranch_vccz L_rb106
    s_cmp_lt_u32 s61, 131072
    s_cbranch_scc1 L_rt105_l
    s_branch L_rb106
L_rt107:
    s_mov_b32 s61, 0
    s_add_u32 s62, s71, 81920
L_rt107_l:
    buffer_load_dwordx4 v[168:171], v8, s[32:35], s62 offen sc1
    buffer_load_dwordx4 v[172:175], v9, s[32:35], s62 offen sc1
    s_add_u32 s61, s61, 1
    s_waitcnt vmcnt(0)
    v_max3_u32 v12, v168, v169, v170
    v_max3_u32 v12, v12, v171, v172
    v_max3_u32 v12, v12, v173, v174
    v_max_u32 v12, v12, v175
    v_cmp_eq_u32 vcc, -1, v12
    s_nop 4
    s_cbranch_vccz L_rb108
    s_cmp_lt_u32 s61, 131072
    s_cbranch_scc1 L_rt107_l
    s_branch L_rb108
L_rt109:
    s_mov_b32 s61, 0
    s_add_u32 s62, s71, 98304
L_rt109_l:
    buffer_load_dwordx4 v[176:179], v8, s[32:35], s62 offen sc1
    buffer_load_dwordx4 v[180:183], v9, s[32:35], s62 offen sc1
    s_add_u32 s61, s61, 1
    s_waitcnt vmcnt(0)
    v_max3_u32 v12, v176, v177, v178
    v_max3_u32 v12, v12, v179, v180
    v_max3_u32 v12, v12, v181, v182
    v_max_u32 v12, v12, v183
    v_cmp_eq_u32 vcc, -1, v12
    s_nop 4
    s_cbranch_vccz L_rb110
    s_cmp_lt_u32 s61, 131072
    s_cbranch_scc1 L_rt109_l
    s_branch L_rb110
L_rt111:
    s_mov_b32 s61, 0
    s_add_u32 s62, s71, 114688
L_rt111_l:
    buffer_load_dwordx4 v[184:187], v8, s[32:35], s62 offen sc1
    buffer_load_dwordx4 v[188:191], v9, s[32:35], s62 offen sc1
    s_add_u32 s61, s61, 1
    s_waitcnt vmcnt(0)
    v_max3_u32 v12, v184, v185, v186
    v_max3_u32 v12, v12, v187, v188
    v_max3_u32 v12, v12, v189, v190
    v_max_u32 v12, v12, v191
    v_cmp_eq_u32 vcc, -1, v12
    s_nop 4
    s_cbranch_vccz L_rb112
    s_cmp_lt_u32 s61, 131072
    s_cbranch_scc1 L_rt111_l
    s_branch L_rb112
L_rt113:
    s_mov_b32 s61, 0
    s_add_u32 s62, s71, 131072
L_rt113_l:
    buffer_load_dwordx4 v[192:195], v8, s[32:35], s62 offen sc1
    buffer_load_dwordx4 v[196:199], v9, s[32:35], s62 offen sc1
    s_add_u32 s61, s61, 1
    s_waitcnt vmcnt(0)
    v_max3_u32 v12, v192, v193, v194
    v_max3_u32 v12, v12, v195, v196
    v_max3_u32 v12, v12, v197, v198
    v_max_u32 v12, v12, v199
    v_cmp_eq_u32 vcc, -1, v12
    s_nop 4
    s_cbranch_vccz L_rb114
    s_cmp_lt_u32 s61, 131072
    s_cbranch_scc1 L_rt113_l
    s_branch L_rb114
L_rt115:
    s_mov_b32 s61, 0
    s_add_u32 s62, s71, 147456
L_rt115_l:
    buffer_load_dwordx4 v[200:203], v8, s[32:35], s62 offen sc1
    buffer_load_dwordx4 v[204:207], v9, s[32:35], s62 offen sc1
    s_add_u32 s61, s61, 1
    s_waitcnt vmcnt(0)
    v_max3_u32 v12, v200, v201, v202
    v_max3_u32 v12, v12, v203, v204
    v_max3_u32 v12, v12, v205, v206
    v_max_u32 v12, v12, v207
    v_cmp_eq_u32 vcc, -1, v12
    s_nop 4
    s_cbranch_vccz L_rb116
    s_cmp_lt_u32 s61, 131072
    s_cbranch_scc1 L_rt115_l
    s_branch L_rb116
L_rt117:
    s_mov_b32 s61, 0
    s_add_u32 s62, s71, 163840
L_rt117_l:
    buffer_load_dwordx4 v[208:211], v8, s[32:35], s62 offen sc1
    buffer_load_dwordx4 v[212:215], v9, s[32:35], s62 offen sc1
    s_add_u32 s61, s61, 1
    s_waitcnt vmcnt(0)
    v_max3_u32 v12, v208, v209, v210
    v_max3_u32 v12, v12, v211, v212
    v_max3_u32 v12, v12, v213, v214
    v_max_u32 v12, v12, v215
    v_cmp_eq_u32 vcc, -1, v12
    s_nop 4
    s_cbranch_vccz L_rb118
    s_cmp_lt_u32 s61, 131072
    s_cbranch_scc1 L_rt117_l
    s_branch L_rb118
L_rt119:
    s_mov_b32 s61, 0
    s_add_u32 s62, s71, 180224
L_rt119_l:
    buffer_load_dwordx4 v[216:219], v8, s[32:35], s62 offen sc1
    buffer_load_dwordx4 v[220:223], v9, s[32:35], s62 offen sc1
    s_add_u32 s61, s61, 1
    s_waitcnt vmcnt(0)
    v_max3_u32 v12, v216, v217, v218
    v_max3_u32 v12, v12, v219, v220
    v_max3_u32 v12, v12, v221, v222
    v_max_u32 v12, v12, v223
    v_cmp_eq_u32 vcc, -1, v12
    s_nop 4
    s_cbranch_vccz L_rb120
    s_cmp_lt_u32 s61, 131072
    s_cbranch_scc1 L_rt119_l
    s_branch L_rb120
L_rt121:
    s_mov_b32 s61, 0
    s_add_u32 s62, s71, 196608
L_rt121_l:
    buffer_load_dwordx4 v[224:227], v8, s[32:35], s62 offen sc1
    buffer_load_dwordx4 v[228:231], v9, s[32:35], s62 offen sc1
    s_add_u32 s61, s61, 1
    s_waitcnt vmcnt(0)
    v_max3_u32 v12, v224, v225, v226
    v_max3_u32 v12, v12, v227, v228
    v_max3_u32 v12, v12, v229, v230
    v_max_u32 v12, v12, v231
    v_cmp_eq_u32 vcc, -1, v12
    s_nop 4
    s_cbranch_vccz L_rb122
    s_cmp_lt_u32 s61, 131072
    s_cbranch_scc1 L_rt121_l
    s_branch L_rb122
L_rt123:
    s_mov_b32 s61, 0
    s_add_u32 s62, s71, 212992
L_rt123_l:
    buffer_load_dwordx4 v[232:235], v8, s[32:35], s62 offen sc1
    buffer_load_dwordx4 v[236:239], v9, s[32:35], s62 offen sc1
    s_add_u32 s61, s61, 1
    s_waitcnt vmcnt(0)
    v_max3_u32 v12, v232, v233, v234
    v_max3_u32 v12, v12, v235, v236
    v_max3_u32 v12, v12, v237, v238
    v_max_u32 v12, v12, v239
    v_cmp_eq_u32 vcc, -1, v12
    s_nop 4
    s_cbranch_vccz L_rb124
    s_cmp_lt_u32 s61, 131072
    s_cbranch_scc1 L_rt123_l
    s_branch L_rb124
L_rt125:
    s_mov_b32 s61, 0
    s_add_u32 s62, s71, 229376
L_rt125_l:
    buffer_load_dwordx4 v[128:131], v8, s[32:35], s62 offen sc1
    buffer_load_dwordx4 v[132:135], v9, s[32:35], s62 offen sc1
    s_add_u32 s61, s61, 1
    s_waitcnt vmcnt(0)
    v_max3_u32 v12, v128, v129, v130
    v_max3_u32 v12, v12, v131, v132
    v_max3_u32 v12, v12, v133, v134
    v_max_u32 v12, v12, v135
    v_cmp_eq_u32 vcc, -1, v12
    s_nop 4
    s_cbranch_vccz L_rb126
    s_cmp_lt_u32 s61, 131072
    s_cbranch_scc1 L_rt125_l
    s_branch L_rb126
L_rt127:
    s_mov_b32 s61, 0
    s_add_u32 s62, s71, 245760
L_rt127_l:
    buffer_load_dwordx4 v[136:139], v8, s[32:35], s62 offen sc1
    buffer_load_dwordx4 v[140:143], v9, s[32:35], s62 offen sc1
    s_add_u32 s61, s61, 1
    s_waitcnt vmcnt(0)
    v_max3_u32 v12, v136, v137, v138
    v_max3_u32 v12, v12, v139, v140
    v_max3_u32 v12, v12, v141, v142
    v_max_u32 v12, v12, v143
    v_cmp_eq_u32 vcc, -1, v12
    s_nop 4
    s_cbranch_vccz L_rb128
    s_cmp_lt_u32 s61, 131072
    s_cbranch_scc1 L_rt127_l
    s_branch L_rb128
L_rt129:
    s_mov_b32 s61, 0
    s_add_u32 s62, s71, 262144
L_rt129_l:
    buffer_load_dwordx4 v[144:147], v8, s[32:35], s62 offen sc1
    buffer_load_dwordx4 v[148:151], v9, s[32:35], s62 offen sc1
    s_add_u32 s61, s61, 1
    s_waitcnt vmcnt(0)
    v_max3_u32 v12, v144, v145, v146
    v_max3_u32 v12, v12, v147, v148
    v_max3_u32 v12, v12, v149, v150
    v_max_u32 v12, v12, v151
    v_cmp_eq_u32 vcc, -1, v12
    s_nop 4
    s_cbranch_vccz L_rb130
    s_cmp_lt_u32 s61, 131072
    s_cbranch_scc1 L_rt129_l
    s_branch L_rb130
L_rt131:
    s_mov_b32 s61, 0
    s_add_u32 s62, s71, 278528
L_rt131_l:
    buffer_load_dwordx4 v[152:155], v8, s[32:35], s62 offen sc1
    buffer_load_dwordx4 v[156:159], v9, s[32:35], s62 offen sc1
    s_add_u32 s61, s61, 1
    s_waitcnt vmcnt(0)
    v_max3_u32 v12, v152, v153, v154
    v_max3_u32 v12, v12, v155, v156
    v_max3_u32 v12, v12, v157, v158
    v_max_u32 v12, v12, v159
    v_cmp_eq_u32 vcc, -1, v12
    s_nop 4
    s_cbranch_vccz L_rb132
    s_cmp_lt_u32 s61, 131072
    s_cbranch_scc1 L_rt131_l
    s_branch L_rb132
L_rt133:
    s_mov_b32 s61, 0
    s_add_u32 s62, s71, 294912
L_rt133_l:
    buffer_load_dwordx4 v[160:163], v8, s[32:35], s62 offen sc1
    buffer_load_dwordx4 v[164:167], v9, s[32:35], s62 offen sc1
    s_add_u32 s61, s61, 1
    s_waitcnt vmcnt(0)
    v_max3_u32 v12, v160, v161, v162
    v_max3_u32 v12, v12, v163, v164
    v_max3_u32 v12, v12, v165, v166
    v_max_u32 v12, v12, v167
    v_cmp_eq_u32 vcc, -1, v12
    s_nop 4
    s_cbranch_vccz L_rb134
    s_cmp_lt_u32 s61, 131072
    s_cbranch_scc1 L_rt133_l
    s_branch L_rb134
L_rt135:
    s_mov_b32 s61, 0
    s_add_u32 s62, s71, 311296
L_rt135_l:
    buffer_load_dwordx4 v[168:171], v8, s[32:35], s62 offen sc1
    buffer_load_dwordx4 v[172:175], v9, s[32:35], s62 offen sc1
    s_add_u32 s61, s61, 1
    s_waitcnt vmcnt(0)
    v_max3_u32 v12, v168, v169, v170
    v_max3_u32 v12, v12, v171, v172
    v_max3_u32 v12, v12, v173, v174
    v_max_u32 v12, v12, v175
    v_cmp_eq_u32 vcc, -1, v12
    s_nop 4
    s_cbranch_vccz L_rb136
    s_cmp_lt_u32 s61, 131072
    s_cbranch_scc1 L_rt135_l
    s_branch L_rb136
L_rt137:
    s_mov_b32 s61, 0
    s_add_u32 s62, s71, 327680
L_rt137_l:
    buffer_load_dwordx4 v[176:179], v8, s[32:35], s62 offen sc1
    buffer_load_dwordx4 v[180:183], v9, s[32:35], s62 offen sc1
    s_add_u32 s61, s61, 1
    s_waitcnt vmcnt(0)
    v_max3_u32 v12, v176, v177, v178
    v_max3_u32 v12, v12, v179, v180
    v_max3_u32 v12, v12, v181, v182
    v_max_u32 v12, v12, v183
    v_cmp_eq_u32 vcc, -1, v12
    s_nop 4
    s_cbranch_vccz L_rb138
    s_cmp_lt_u32 s61, 131072
    s_cbranch_scc1 L_rt137_l
    s_branch L_rb138
L_rt139:
    s_mov_b32 s61, 0
    s_add_u32 s62, s71, 344064
L_rt139_l:
    buffer_load_dwordx4 v[184:187], v8, s[32:35], s62 offen sc1
    buffer_load_dwordx4 v[188:191], v9, s[32:35], s62 offen sc1
    s_add_u32 s61, s61, 1
    s_waitcnt vmcnt(0)
    v_max3_u32 v12, v184, v185, v186
    v_max3_u32 v12, v12, v187, v188
    v_max3_u32 v12, v12, v189, v190
    v_max_u32 v12, v12, v191
    v_cmp_eq_u32 vcc, -1, v12
    s_nop 4
    s_cbranch_vccz L_rb140
    s_cmp_lt_u32 s61, 131072
    s_cbranch_scc1 L_rt139_l
    s_branch L_rb140
L_rt141:
    s_mov_b32 s61, 0
    s_add_u32 s62, s71, 360448
L_rt141_l:
    buffer_load_dwordx4 v[192:195], v8, s[32:35], s62 offen sc1
    buffer_load_dwordx4 v[196:199], v9, s[32:35], s62 offen sc1
    s_add_u32 s61, s61, 1
    s_waitcnt vmcnt(0)
    v_max3_u32 v12, v192, v193, v194
    v_max3_u32 v12, v12, v195, v196
    v_max3_u32 v12, v12, v197, v198
    v_max_u32 v12, v12, v199
    v_cmp_eq_u32 vcc, -1, v12
    s_nop 4
    s_cbranch_vccz L_rb142
    s_cmp_lt_u32 s61, 131072
    s_cbranch_scc1 L_rt141_l
    s_branch L_rb142
L_rt143:
    s_mov_b32 s61, 0
    s_add_u32 s62, s71, 376832
L_rt143_l:
    buffer_load_dwordx4 v[200:203], v8, s[32:35], s62 offen sc1
    buffer_load_dwordx4 v[204:207], v9, s[32:35], s62 offen sc1
    s_add_u32 s61, s61, 1
    s_waitcnt vmcnt(0)
    v_max3_u32 v12, v200, v201, v202
    v_max3_u32 v12, v12, v203, v204
    v_max3_u32 v12, v12, v205, v206
    v_max_u32 v12, v12, v207
    v_cmp_eq_u32 vcc, -1, v12
    s_nop 4
    s_cbranch_vccz L_rb144
    s_cmp_lt_u32 s61, 131072
    s_cbranch_scc1 L_rt143_l
    s_branch L_rb144
L_rt145:
    s_mov_b32 s61, 0
    s_add_u32 s62, s71, 393216
L_rt145_l:
    buffer_load_dwordx4 v[208:211], v8, s[32:35], s62 offen sc1
    buffer_load_dwordx4 v[212:215], v9, s[32:35], s62 offen sc1
    s_add_u32 s61, s61, 1
    s_waitcnt vmcnt(0)
    v_max3_u32 v12, v208, v209, v210
    v_max3_u32 v12, v12, v211, v212
    v_max3_u32 v12, v12, v213, v214
    v_max_u32 v12, v12, v215
    v_cmp_eq_u32 vcc, -1, v12
    s_nop 4
    s_cbranch_vccz L_rb146
    s_cmp_lt_u32 s61, 131072
    s_cbranch_scc1 L_rt145_l
    s_branch L_rb146
L_rt147:
    s_mov_b32 s61, 0
    s_add_u32 s62, s71, 409600
L_rt147_l:
    buffer_load_dwordx4 v[216:219], v8, s[32:35], s62 offen sc1
    buffer_load_dwordx4 v[220:223], v9, s[32:35], s62 offen sc1
    s_add_u32 s61, s61, 1
    s_waitcnt vmcnt(0)
    v_max3_u32 v12, v216, v217, v218
    v_max3_u32 v12, v12, v219, v220
    v_max3_u32 v12, v12, v221, v222
    v_max_u32 v12, v12, v223
    v_cmp_eq_u32 vcc, -1, v12
    s_nop 4
    s_cbranch_vccz L_rb148
    s_cmp_lt_u32 s61, 131072
    s_cbranch_scc1 L_rt147_l
    s_branch L_rb148
L_rt149:
    s_mov_b32 s61, 0
    s_add_u32 s62, s71, 425984
L_rt149_l:
    buffer_load_dwordx4 v[224:227], v8, s[32:35], s62 offen sc1
    buffer_load_dwordx4 v[228:231], v9, s[32:35], s62 offen sc1
    s_add_u32 s61, s61, 1
    s_waitcnt vmcnt(0)
    v_max3_u32 v12, v224, v225, v226
    v_max3_u32 v12, v12, v227, v228
    v_max3_u32 v12, v12, v229, v230
    v_max_u32 v12, v12, v231
    v_cmp_eq_u32 vcc, -1, v12
    s_nop 4
    s_cbranch_vccz L_rb150
    s_cmp_lt_u32 s61, 131072
    s_cbranch_scc1 L_rt149_l
    s_branch L_rb150
L_rt151:
    s_mov_b32 s61, 0
    s_add_u32 s62, s71, 442368
L_rt151_l:
    buffer_load_dwordx4 v[232:235], v8, s[32:35], s62 offen sc1
    buffer_load_dwordx4 v[236:239], v9, s[32:35], s62 offen sc1
    s_add_u32 s61, s61, 1
    s_waitcnt vmcnt(0)
    v_max3_u32 v12, v232, v233, v234
    v_max3_u32 v12, v12, v235, v236
    v_max3_u32 v12, v12, v237, v238
    v_max_u32 v12, v12, v239
    v_cmp_eq_u32 vcc, -1, v12
    s_nop 4
    s_cbranch_vccz L_rb152
    s_cmp_lt_u32 s61, 131072
    s_cbranch_scc1 L_rt151_l
    s_branch L_rb152
L_code_end:
    s_endpgm
.section .rodata,"a"
.p2align 6
.amdhsa_kernel sequential_preLN__ssm_conv_s4__mixer_token_mlp__prompt_kernel
  .amdhsa_next_free_vgpr 512
  .amdhsa_next_free_sgpr 100
  .amdhsa_accum_offset 256
  .amdhsa_group_segment_fixed_size 0
  .amdhsa_kernarg_size 136
  .amdhsa_user_sgpr_count 2
  .amdhsa_user_sgpr_kernarg_segment_ptr 1
  .amdhsa_system_sgpr_workgroup_id_x 1
  .amdhsa_float_denorm_mode_32 3
.end_amdhsa_kernel
```
